```python
import torch

def _softmax(x, axis=-1):
    return torch.softmax(x, dim=axis)
def _gelu(x):
    return torch.nn.functional.gelu(x, approximate="tanh")
def _silu(x):
    return torch.nn.functional.silu(x)
def _sigmoid(x):
    return torch.sigmoid(x)
def _layernorm(x, axis=-1, eps=1e-5):
    m = x.mean(dim=axis, keepdim=True)
    v = x.var(dim=axis, keepdim=True, unbiased=False)
    return (x - m) / torch.sqrt(v + eps)
def _scatter_add(tgt, idx, src, axis=0):
    return tgt.clone().index_add_(axis, idx, src)
def _segment_sum(src, seg, n):
    out = torch.zeros((n,) + src.shape[1:], dtype=src.dtype)
    return out.index_add_(0, seg, src)
def _pad(x, pw):
    flat = tuple(v for pair in reversed(pw) for v in pair)
    return torch.nn.functional.pad(x, flat)

kernel_name = 'standalone__gqa_block_cached__sampling'

def setup_inputs():

    _w = (lambda a: (lambda t: t.to(torch.bfloat16) if t.is_floating_point() else t)(torch.as_tensor(a)))
    B, Sq, D = 32, 4, 576
    Hq, Hkv, Sk, Dh = 32, 16, 2048, 128
    assert Hq % Hkv == 0, (Hq, Hkv)
    return {
        "x": _w((lambda *s: torch.randn(*s, dtype=torch.bfloat16) * 0.8)(B, Sq, D)),
        "k_cache": _w((lambda *s: torch.randn(*s, dtype=torch.bfloat16) * 0.8)(B, Hkv, Sk, Dh)),
        "v_cache": _w((lambda *s: torch.randn(*s, dtype=torch.bfloat16) * 0.05)(B, Hkv, Sk, Dh)),
        "wq": _w((lambda *s: torch.randn(*s, dtype=torch.bfloat16) * 0.8)(D, Hq * Dh) * (D ** -0.5)),
        "wo": _w((lambda *s: torch.randn(*s, dtype=torch.bfloat16) * 0.05)(Hq * Dh, D) * ((Hq * Dh) ** -0.5)),
    }

def reference(x, k_cache, v_cache, wq, wo):
    B, Sq, D = x.shape
    Hq, Dh = 32, 128
    Hkv = k_cache.shape[1]
    rep = Hq // Hkv
    q = (lambda x, *d: x.permute(*d))((x @ wq).reshape(B, Sq, Hq, Dh), 0, 2, 1, 3)
    k = (lambda x, n, axis: torch.repeat_interleave(x, n, dim=axis))(k_cache, rep, axis=1)
    v = (lambda x, n, axis: torch.repeat_interleave(x, n, dim=axis))(v_cache, rep, axis=1)
    scores = torch.einsum("bhqd,bhkd->bhqk", q, k) * (Dh ** -0.5)
    p = _softmax(scores, axis=-1)
    o = torch.einsum("bhqk,bhkd->bhqd", p, v)
    return (lambda x, *d: x.permute(*d))(o, 0, 2, 1, 3).reshape(B, Sq, Hq * Dh) @ wo
```

```asm
; @launch kernel=gqa_main_kernel grid=(256,1,1) block=(512,1,1) lds=163840
; @launch kernel=gqa_reduce_kernel grid=(144,1,1) block=(128,1,1) lds=0
.amdgcn_target "amdgcn-amd-amdhsa--gfx950"
.text
.globl gqa_main_kernel
.p2align 8
.type gqa_main_kernel,@function
gqa_main_kernel:
    s_cmp_ge_u32 s2, 256
    s_cbranch_scc1 L1_end
    s_load_dwordx16 s[4:19], s[0:1], 0
    v_lshrrev_b32 v1, 6, v0
    v_and_b32 v0, 63, v0
    v_and_b32 v9, 15, v0
    v_readfirstlane_b32 s47, v1
    v_lshrrev_b32 v10, 4, v0
    s_bfe_u32 s48, s2, 0x30000
    s_lshl_b32 s48, s48, 1
    s_bfe_u32 s53, s2, 0x10003
    s_add_u32 s48, s48, s53
    s_lshr_b32 s49, s2, 4
    s_lshr_b32 s63, 0xffc0, s49
    s_and_b32 s63, s63, 1
    s_mul_i32 s63, s63, 21840
    s_mov_b32 s44, 0x05040100
    s_mov_b32 s45, 0x07060302
    s_sub_u32 s57, s47, 2
    s_mov_b32 s59, s47
    s_cmp_ge_u32 s47, 2
    s_cbranch_scc1 L1_helper
    s_mov_b32 s46, 0x3e0293ee
    s_movk_i32 s52, 0x1000
    s_lshl_b32 s54, s59, 13
    v_bfe_u32 v1, v0, 1, 1
    v_bfe_u32 v7, v0, 2, 2
    v_lshl_add_u32 v1, v1, 2, v7
    v_lshlrev_b32 v1, 8, v1
    v_lshl_add_u32 v1, v10, 5, v1
    v_and_b32 v7, 1, v0
    v_lshl_add_u32 v1, v7, 4, v1
    v_add_u32 v1, s54, v1
    v_lshlrev_b32 v208, 4, v0
    v_add_u32 v2, s54, v208
    s_lshl_b32 s53, s49, 5
    s_add_u32 s53, s53, s48
    s_lshl_b32 s53, s53, 19
    s_mul_i32 s56, s59, 56832
    s_add_u32 s55, s56, 57856
    v_add_u32 v208, s55, v208
    s_waitcnt lgkmcnt(0)
    s_add_u32 s20, s6, s53
    s_addc_u32 s21, s7, 0
    s_mov_b32 s22, 0x880000
    s_mov_b32 s23, 0x20000
    s_cmp_eq_u32 s63, 0
    s_cbranch_scc1 L1_sb
    s_bitcmp1_b32 0x7c0, s49
    s_cbranch_scc0 L1_sa
    v_add_u32 v211, 0x10000, v1
    s_add_u32 m0, s55, 0
    s_nop 0
    buffer_load_dwordx4 v211, s[20:23], 0 offen offset:0 nt lds
    buffer_load_dwordx4 v211, s[20:23], 0 offen offset:2048 nt lds
    s_add_u32 m0, s55, 896
    s_nop 0
    buffer_load_dwordx4 v211, s[20:23], 0 offen offset:128 nt lds
    buffer_load_dwordx4 v211, s[20:23], 0 offen offset:2176 nt lds
    s_add_u32 m0, s55, 4096
    s_nop 0
    buffer_load_dwordx4 v211, s[20:23], s52 offen offset:0 nt lds
    buffer_load_dwordx4 v211, s[20:23], s52 offen offset:2048 nt lds
    s_add_u32 m0, s55, 4992
    s_nop 0
    buffer_load_dwordx4 v211, s[20:23], s52 offen offset:128 nt lds
    buffer_load_dwordx4 v211, s[20:23], s52 offen offset:2176 nt lds
    v_add_u32 v211, 0x18000, v1
    s_add_u32 m0, s55, 8192
    s_nop 0
    buffer_load_dwordx4 v211, s[20:23], 0 offen offset:0 nt lds
    buffer_load_dwordx4 v211, s[20:23], 0 offen offset:2048 nt lds
    s_add_u32 m0, s55, 9088
    s_nop 0
    buffer_load_dwordx4 v211, s[20:23], 0 offen offset:128 nt lds
    buffer_load_dwordx4 v211, s[20:23], 0 offen offset:2176 nt lds
    s_add_u32 m0, s55, 12288
    s_nop 0
    buffer_load_dwordx4 v211, s[20:23], s52 offen offset:0 nt lds
    buffer_load_dwordx4 v211, s[20:23], s52 offen offset:2048 nt lds
    s_add_u32 m0, s55, 13184
    s_nop 0
    buffer_load_dwordx4 v211, s[20:23], s52 offen offset:128 nt lds
    buffer_load_dwordx4 v211, s[20:23], s52 offen offset:2176 nt lds
    v_add_u32 v211, 0x20000, v1
    s_add_u32 m0, s55, 16384
    s_nop 0
    buffer_load_dwordx4 v211, s[20:23], 0 offen offset:0 nt lds
    buffer_load_dwordx4 v211, s[20:23], 0 offen offset:2048 nt lds
    s_add_u32 m0, s55, 17280
    s_nop 0
    buffer_load_dwordx4 v211, s[20:23], 0 offen offset:128 nt lds
    buffer_load_dwordx4 v211, s[20:23], 0 offen offset:2176 nt lds
    s_add_u32 m0, s55, 20480
    s_nop 0
    buffer_load_dwordx4 v211, s[20:23], s52 offen offset:0 nt lds
    buffer_load_dwordx4 v211, s[20:23], s52 offen offset:2048 nt lds
    s_add_u32 m0, s55, 21376
    s_nop 0
    buffer_load_dwordx4 v211, s[20:23], s52 offen offset:128 nt lds
    buffer_load_dwordx4 v211, s[20:23], s52 offen offset:2176 nt lds
    v_add_u32 v211, 0x28000, v1
    s_add_u32 m0, s55, 24576
    s_nop 0
    buffer_load_dwordx4 v211, s[20:23], 0 offen offset:0 nt lds
    buffer_load_dwordx4 v211, s[20:23], 0 offen offset:2048 nt lds
    s_add_u32 m0, s55, 25472
    s_nop 0
    buffer_load_dwordx4 v211, s[20:23], 0 offen offset:128 nt lds
    buffer_load_dwordx4 v211, s[20:23], 0 offen offset:2176 nt lds
    s_add_u32 m0, s55, 28672
    s_nop 0
    buffer_load_dwordx4 v211, s[20:23], s52 offen offset:0 nt lds
    buffer_load_dwordx4 v211, s[20:23], s52 offen offset:2048 nt lds
    s_add_u32 m0, s55, 29568
    s_nop 0
    buffer_load_dwordx4 v211, s[20:23], s52 offen offset:128 nt lds
    buffer_load_dwordx4 v211, s[20:23], s52 offen offset:2176 nt lds
    v_add_u32 v211, 0x30000, v1
    s_add_u32 m0, s55, 32768
    s_nop 0
    buffer_load_dwordx4 v211, s[20:23], 0 offen offset:0 nt lds
    buffer_load_dwordx4 v211, s[20:23], 0 offen offset:2048 nt lds
    s_add_u32 m0, s55, 33664
    s_nop 0
    buffer_load_dwordx4 v211, s[20:23], 0 offen offset:128 nt lds
    buffer_load_dwordx4 v211, s[20:23], 0 offen offset:2176 nt lds
    s_add_u32 m0, s55, 36864
    s_nop 0
    buffer_load_dwordx4 v211, s[20:23], s52 offen offset:0 nt lds
    buffer_load_dwordx4 v211, s[20:23], s52 offen offset:2048 nt lds
    s_add_u32 m0, s55, 37760
    s_nop 0
    buffer_load_dwordx4 v211, s[20:23], s52 offen offset:128 nt lds
    buffer_load_dwordx4 v211, s[20:23], s52 offen offset:2176 nt lds
    v_add_u32 v211, 0x38000, v1
    s_add_u32 m0, s55, 40960
    s_nop 0
    buffer_load_dwordx4 v211, s[20:23], 0 offen offset:0 nt lds
    buffer_load_dwordx4 v211, s[20:23], 0 offen offset:2048 nt lds
    s_add_u32 m0, s55, 41856
    s_nop 0
    buffer_load_dwordx4 v211, s[20:23], 0 offen offset:128 nt lds
    buffer_load_dwordx4 v211, s[20:23], 0 offen offset:2176 nt lds
    s_add_u32 m0, s55, 45056
    s_nop 0
    buffer_load_dwordx4 v211, s[20:23], s52 offen offset:0 nt lds
    buffer_load_dwordx4 v211, s[20:23], s52 offen offset:2048 nt lds
    s_add_u32 m0, s55, 45952
    s_nop 0
    buffer_load_dwordx4 v211, s[20:23], s52 offen offset:128 nt lds
    buffer_load_dwordx4 v211, s[20:23], s52 offen offset:2176 nt lds
    buffer_load_dwordx4 v[80:83], v1, s[20:23], 0 offen offset:0 nt
    buffer_load_dwordx4 v[84:87], v1, s[20:23], 0 offen offset:128 nt
    buffer_load_dwordx4 v[88:91], v1, s[20:23], 0 offen offset:2048 nt
    buffer_load_dwordx4 v[92:95], v1, s[20:23], 0 offen offset:2176 nt
    buffer_load_dwordx4 v[96:99], v1, s[20:23], s52 offen offset:0 nt
    buffer_load_dwordx4 v[100:103], v1, s[20:23], s52 offen offset:128 nt
    buffer_load_dwordx4 v[104:107], v1, s[20:23], s52 offen offset:2048 nt
    buffer_load_dwordx4 v[108:111], v1, s[20:23], s52 offen offset:2176 nt
    v_add_u32 v1, 0x4000, v1
    buffer_load_dwordx4 v[112:115], v1, s[20:23], 0 offen offset:0 nt
    buffer_load_dwordx4 v[116:119], v1, s[20:23], 0 offen offset:128 nt
    buffer_load_dwordx4 v[120:123], v1, s[20:23], 0 offen offset:2048 nt
    buffer_load_dwordx4 v[124:127], v1, s[20:23], 0 offen offset:2176 nt
    buffer_load_dwordx4 v[128:131], v1, s[20:23], s52 offen offset:0 nt
    buffer_load_dwordx4 v[132:135], v1, s[20:23], s52 offen offset:128 nt
    buffer_load_dwordx4 v[136:139], v1, s[20:23], s52 offen offset:2048 nt
    buffer_load_dwordx4 v[140:143], v1, s[20:23], s52 offen offset:2176 nt
    v_add_u32 v1, 0x4000, v1
    s_barrier
    s_barrier
    buffer_load_dwordx4 v[144:147], v1, s[20:23], 0 offen offset:0 nt
    buffer_load_dwordx4 v[148:151], v1, s[20:23], 0 offen offset:128 nt
    buffer_load_dwordx4 v[152:155], v1, s[20:23], 0 offen offset:2048 nt
    buffer_load_dwordx4 v[156:159], v1, s[20:23], 0 offen offset:2176 nt
    buffer_load_dwordx4 v[160:163], v1, s[20:23], s52 offen offset:0 nt
    buffer_load_dwordx4 v[164:167], v1, s[20:23], s52 offen offset:128 nt
    buffer_load_dwordx4 v[168:171], v1, s[20:23], s52 offen offset:2048 nt
    buffer_load_dwordx4 v[172:175], v1, s[20:23], s52 offen offset:2176 nt
    v_add_u32 v1, 0x4000, v1
    buffer_load_dwordx4 v[176:179], v1, s[20:23], 0 offen offset:0 nt
    buffer_load_dwordx4 v[180:183], v1, s[20:23], 0 offen offset:128 nt
    buffer_load_dwordx4 v[184:187], v1, s[20:23], 0 offen offset:2048 nt
    buffer_load_dwordx4 v[188:191], v1, s[20:23], 0 offen offset:2176 nt
    buffer_load_dwordx4 v[192:195], v1, s[20:23], s52 offen offset:0 nt
    buffer_load_dwordx4 v[196:199], v1, s[20:23], s52 offen offset:128 nt
    buffer_load_dwordx4 v[200:203], v1, s[20:23], s52 offen offset:2048 nt
    buffer_load_dwordx4 v[204:207], v1, s[20:23], s52 offen offset:2176 nt
    v_add_u32 v1, 0x4000, v1
    s_mov_b32 s51, 12
    s_mov_b32 s92, 0x1e000
    s_branch L1_sj
L1_sa:
    v_add_u32 v211, 0x10000, v1
    s_add_u32 m0, s55, 0
    s_nop 0
    buffer_load_dwordx4 v211, s[20:23], 0 offen offset:0 nt lds
    buffer_load_dwordx4 v211, s[20:23], 0 offen offset:2048 nt lds
    s_add_u32 m0, s55, 896
    s_nop 0
    buffer_load_dwordx4 v211, s[20:23], 0 offen offset:128 nt lds
    buffer_load_dwordx4 v211, s[20:23], 0 offen offset:2176 nt lds
    s_add_u32 m0, s55, 4096
    s_nop 0
    buffer_load_dwordx4 v211, s[20:23], s52 offen offset:0 nt lds
    buffer_load_dwordx4 v211, s[20:23], s52 offen offset:2048 nt lds
    s_add_u32 m0, s55, 4992
    s_nop 0
    buffer_load_dwordx4 v211, s[20:23], s52 offen offset:128 nt lds
    buffer_load_dwordx4 v211, s[20:23], s52 offen offset:2176 nt lds
    v_add_u32 v211, 0x18000, v1
    s_add_u32 m0, s55, 8192
    s_nop 0
    buffer_load_dwordx4 v211, s[20:23], 0 offen offset:0 nt lds
    buffer_load_dwordx4 v211, s[20:23], 0 offen offset:2048 nt lds
    s_add_u32 m0, s55, 9088
    s_nop 0
    buffer_load_dwordx4 v211, s[20:23], 0 offen offset:128 nt lds
    buffer_load_dwordx4 v211, s[20:23], 0 offen offset:2176 nt lds
    s_add_u32 m0, s55, 12288
    s_nop 0
    buffer_load_dwordx4 v211, s[20:23], s52 offen offset:0 nt lds
    buffer_load_dwordx4 v211, s[20:23], s52 offen offset:2048 nt lds
    s_add_u32 m0, s55, 13184
    s_nop 0
    buffer_load_dwordx4 v211, s[20:23], s52 offen offset:128 nt lds
    buffer_load_dwordx4 v211, s[20:23], s52 offen offset:2176 nt lds
    v_add_u32 v211, 0x20000, v1
    s_add_u32 m0, s55, 16384
    s_nop 0
    buffer_load_dwordx4 v211, s[20:23], 0 offen offset:0 nt lds
    buffer_load_dwordx4 v211, s[20:23], 0 offen offset:2048 nt lds
    s_add_u32 m0, s55, 17280
    s_nop 0
    buffer_load_dwordx4 v211, s[20:23], 0 offen offset:128 nt lds
    buffer_load_dwordx4 v211, s[20:23], 0 offen offset:2176 nt lds
    s_add_u32 m0, s55, 20480
    s_nop 0
    buffer_load_dwordx4 v211, s[20:23], s52 offen offset:0 nt lds
    buffer_load_dwordx4 v211, s[20:23], s52 offen offset:2048 nt lds
    s_add_u32 m0, s55, 21376
    s_nop 0
    buffer_load_dwordx4 v211, s[20:23], s52 offen offset:128 nt lds
    buffer_load_dwordx4 v211, s[20:23], s52 offen offset:2176 nt lds
    v_add_u32 v211, 0x28000, v1
    s_add_u32 m0, s55, 24576
    s_nop 0
    buffer_load_dwordx4 v211, s[20:23], 0 offen offset:0 nt lds
    buffer_load_dwordx4 v211, s[20:23], 0 offen offset:2048 nt lds
    s_add_u32 m0, s55, 25472
    s_nop 0
    buffer_load_dwordx4 v211, s[20:23], 0 offen offset:128 nt lds
    buffer_load_dwordx4 v211, s[20:23], 0 offen offset:2176 nt lds
    s_add_u32 m0, s55, 28672
    s_nop 0
    buffer_load_dwordx4 v211, s[20:23], s52 offen offset:0 nt lds
    buffer_load_dwordx4 v211, s[20:23], s52 offen offset:2048 nt lds
    s_add_u32 m0, s55, 29568
    s_nop 0
    buffer_load_dwordx4 v211, s[20:23], s52 offen offset:128 nt lds
    buffer_load_dwordx4 v211, s[20:23], s52 offen offset:2176 nt lds
    v_add_u32 v211, 0x30000, v1
    s_add_u32 m0, s55, 32768
    s_nop 0
    buffer_load_dwordx4 v211, s[20:23], 0 offen offset:0 nt lds
    buffer_load_dwordx4 v211, s[20:23], 0 offen offset:2048 nt lds
    s_add_u32 m0, s55, 33664
    s_nop 0
    buffer_load_dwordx4 v211, s[20:23], 0 offen offset:128 nt lds
    buffer_load_dwordx4 v211, s[20:23], 0 offen offset:2176 nt lds
    s_add_u32 m0, s55, 36864
    s_nop 0
    buffer_load_dwordx4 v211, s[20:23], s52 offen offset:0 nt lds
    buffer_load_dwordx4 v211, s[20:23], s52 offen offset:2048 nt lds
    s_add_u32 m0, s55, 37760
    s_nop 0
    buffer_load_dwordx4 v211, s[20:23], s52 offen offset:128 nt lds
    buffer_load_dwordx4 v211, s[20:23], s52 offen offset:2176 nt lds
    v_add_u32 v211, 0x38000, v1
    s_add_u32 m0, s55, 40960
    s_nop 0
    buffer_load_dwordx4 v211, s[20:23], 0 offen offset:0 nt lds
    buffer_load_dwordx4 v211, s[20:23], 0 offen offset:2048 nt lds
    s_add_u32 m0, s55, 41856
    s_nop 0
    buffer_load_dwordx4 v211, s[20:23], 0 offen offset:128 nt lds
    buffer_load_dwordx4 v211, s[20:23], 0 offen offset:2176 nt lds
    s_add_u32 m0, s55, 45056
    s_nop 0
    buffer_load_dwordx4 v211, s[20:23], s52 offen offset:0 nt lds
    buffer_load_dwordx4 v211, s[20:23], s52 offen offset:2048 nt lds
    s_add_u32 m0, s55, 45952
    s_nop 0
    buffer_load_dwordx4 v211, s[20:23], s52 offen offset:128 nt lds
    buffer_load_dwordx4 v211, s[20:23], s52 offen offset:2176 nt lds
    buffer_load_dwordx4 v[80:83], v1, s[20:23], 0 offen offset:0 nt
    buffer_load_dwordx4 v[84:87], v1, s[20:23], 0 offen offset:128 nt
    buffer_load_dwordx4 v[88:91], v1, s[20:23], 0 offen offset:2048 nt
    buffer_load_dwordx4 v[92:95], v1, s[20:23], 0 offen offset:2176 nt
    buffer_load_dwordx4 v[96:99], v1, s[20:23], s52 offen offset:0 nt
    buffer_load_dwordx4 v[100:103], v1, s[20:23], s52 offen offset:128 nt
    buffer_load_dwordx4 v[104:107], v1, s[20:23], s52 offen offset:2048 nt
    buffer_load_dwordx4 v[108:111], v1, s[20:23], s52 offen offset:2176 nt
    v_add_u32 v1, 0x4000, v1
    buffer_load_dwordx4 v[112:115], v1, s[20:23], 0 offen offset:0 nt
    buffer_load_dwordx4 v[116:119], v1, s[20:23], 0 offen offset:128 nt
    buffer_load_dwordx4 v[120:123], v1, s[20:23], 0 offen offset:2048 nt
    buffer_load_dwordx4 v[124:127], v1, s[20:23], 0 offen offset:2176 nt
    buffer_load_dwordx4 v[128:131], v1, s[20:23], s52 offen offset:0 nt
    buffer_load_dwordx4 v[132:135], v1, s[20:23], s52 offen offset:128 nt
    buffer_load_dwordx4 v[136:139], v1, s[20:23], s52 offen offset:2048 nt
    buffer_load_dwordx4 v[140:143], v1, s[20:23], s52 offen offset:2176 nt
    v_add_u32 v1, 0x4000, v1
    buffer_load_dwordx4 v[144:147], v1, s[20:23], 0 offen offset:0 nt
    buffer_load_dwordx4 v[148:151], v1, s[20:23], 0 offen offset:128 nt
    buffer_load_dwordx4 v[152:155], v1, s[20:23], 0 offen offset:2048 nt
    buffer_load_dwordx4 v[156:159], v1, s[20:23], 0 offen offset:2176 nt
    buffer_load_dwordx4 v[160:163], v1, s[20:23], s52 offen offset:0 nt
    buffer_load_dwordx4 v[164:167], v1, s[20:23], s52 offen offset:128 nt
    buffer_load_dwordx4 v[168:171], v1, s[20:23], s52 offen offset:2048 nt
    buffer_load_dwordx4 v[172:175], v1, s[20:23], s52 offen offset:2176 nt
    v_add_u32 v1, 0x4000, v1
    buffer_load_dwordx4 v[176:179], v1, s[20:23], 0 offen offset:0 nt
    buffer_load_dwordx4 v[180:183], v1, s[20:23], 0 offen offset:128 nt
    buffer_load_dwordx4 v[184:187], v1, s[20:23], 0 offen offset:2048 nt
    buffer_load_dwordx4 v[188:191], v1, s[20:23], 0 offen offset:2176 nt
    buffer_load_dwordx4 v[192:195], v1, s[20:23], s52 offen offset:0 nt
    buffer_load_dwordx4 v[196:199], v1, s[20:23], s52 offen offset:128 nt
    buffer_load_dwordx4 v[200:203], v1, s[20:23], s52 offen offset:2048 nt
    buffer_load_dwordx4 v[204:207], v1, s[20:23], s52 offen offset:2176 nt
    v_add_u32 v1, 0x4000, v1
    s_mov_b32 s54, 81920
    buffer_load_dwordx4 v[240:243], v2, s[20:23], s54 offen offset:0
    buffer_load_dwordx4 v[240:243], v2, s[20:23], s54 offen offset:1024
    buffer_load_dwordx4 v[240:243], v2, s[20:23], s54 offen offset:2048
    buffer_load_dwordx4 v[240:243], v2, s[20:23], s54 offen offset:3072
    s_mov_b32 s54, 86016
    buffer_load_dwordx4 v[240:243], v2, s[20:23], s54 offen offset:0
    buffer_load_dwordx4 v[240:243], v2, s[20:23], s54 offen offset:1024
    buffer_load_dwordx4 v[240:243], v2, s[20:23], s54 offen offset:2048
    buffer_load_dwordx4 v[240:243], v2, s[20:23], s54 offen offset:3072
    s_mov_b32 s54, 147456
    buffer_load_dwordx4 v[240:243], v2, s[20:23], s54 offen offset:0
    buffer_load_dwordx4 v[240:243], v2, s[20:23], s54 offen offset:1024
    buffer_load_dwordx4 v[240:243], v2, s[20:23], s54 offen offset:2048
    buffer_load_dwordx4 v[240:243], v2, s[20:23], s54 offen offset:3072
    s_mov_b32 s54, 151552
    buffer_load_dwordx4 v[240:243], v2, s[20:23], s54 offen offset:0
    buffer_load_dwordx4 v[240:243], v2, s[20:23], s54 offen offset:1024
    buffer_load_dwordx4 v[240:243], v2, s[20:23], s54 offen offset:2048
    buffer_load_dwordx4 v[240:243], v2, s[20:23], s54 offen offset:3072
    s_mov_b32 s54, 212992
    buffer_load_dwordx4 v[240:243], v2, s[20:23], s54 offen offset:0
    buffer_load_dwordx4 v[240:243], v2, s[20:23], s54 offen offset:1024
    buffer_load_dwordx4 v[240:243], v2, s[20:23], s54 offen offset:2048
    buffer_load_dwordx4 v[240:243], v2, s[20:23], s54 offen offset:3072
    s_mov_b32 s54, 217088
    buffer_load_dwordx4 v[240:243], v2, s[20:23], s54 offen offset:0
    buffer_load_dwordx4 v[240:243], v2, s[20:23], s54 offen offset:1024
    buffer_load_dwordx4 v[240:243], v2, s[20:23], s54 offen offset:2048
    buffer_load_dwordx4 v[240:243], v2, s[20:23], s54 offen offset:3072
    s_mov_b32 s54, 262144
    buffer_load_dwordx4 v[240:243], v2, s[20:23], s54 offen offset:0
    buffer_load_dwordx4 v[240:243], v2, s[20:23], s54 offen offset:1024
    buffer_load_dwordx4 v[240:243], v2, s[20:23], s54 offen offset:2048
    buffer_load_dwordx4 v[240:243], v2, s[20:23], s54 offen offset:3072
    s_mov_b32 s54, 266240
    buffer_load_dwordx4 v[240:243], v2, s[20:23], s54 offen offset:0
    buffer_load_dwordx4 v[240:243], v2, s[20:23], s54 offen offset:1024
    buffer_load_dwordx4 v[240:243], v2, s[20:23], s54 offen offset:2048
    buffer_load_dwordx4 v[240:243], v2, s[20:23], s54 offen offset:3072
    s_barrier
    s_barrier
    s_mov_b32 s54, 294912
    buffer_load_dwordx4 v[240:243], v2, s[20:23], s54 offen offset:0
    buffer_load_dwordx4 v[240:243], v2, s[20:23], s54 offen offset:1024
    buffer_load_dwordx4 v[240:243], v2, s[20:23], s54 offen offset:2048
    buffer_load_dwordx4 v[240:243], v2, s[20:23], s54 offen offset:3072
    s_mov_b32 s54, 299008
    buffer_load_dwordx4 v[240:243], v2, s[20:23], s54 offen offset:0
    buffer_load_dwordx4 v[240:243], v2, s[20:23], s54 offen offset:1024
    buffer_load_dwordx4 v[240:243], v2, s[20:23], s54 offen offset:2048
    buffer_load_dwordx4 v[240:243], v2, s[20:23], s54 offen offset:3072
    s_mov_b32 s54, 327680
    buffer_load_dwordx4 v[240:243], v2, s[20:23], s54 offen offset:0
    buffer_load_dwordx4 v[240:243], v2, s[20:23], s54 offen offset:1024
    buffer_load_dwordx4 v[240:243], v2, s[20:23], s54 offen offset:2048
    buffer_load_dwordx4 v[240:243], v2, s[20:23], s54 offen offset:3072
    s_mov_b32 s54, 331776
    buffer_load_dwordx4 v[240:243], v2, s[20:23], s54 offen offset:0
    buffer_load_dwordx4 v[240:243], v2, s[20:23], s54 offen offset:1024
    buffer_load_dwordx4 v[240:243], v2, s[20:23], s54 offen offset:2048
    buffer_load_dwordx4 v[240:243], v2, s[20:23], s54 offen offset:3072
L1_sa2:
    s_mov_b32 s51, 12
    s_mov_b32 s92, 0x1f000
    s_branch L1_sj
L1_sb:
    s_barrier
    buffer_load_dwordx4 v[80:83], v1, s[20:23], 0 offen offset:0 nt
    buffer_load_dwordx4 v[84:87], v1, s[20:23], 0 offen offset:128 nt
    buffer_load_dwordx4 v[88:91], v1, s[20:23], 0 offen offset:2048 nt
    buffer_load_dwordx4 v[92:95], v1, s[20:23], 0 offen offset:2176 nt
    buffer_load_dwordx4 v[96:99], v1, s[20:23], s52 offen offset:0 nt
    buffer_load_dwordx4 v[100:103], v1, s[20:23], s52 offen offset:128 nt
    buffer_load_dwordx4 v[104:107], v1, s[20:23], s52 offen offset:2048 nt
    buffer_load_dwordx4 v[108:111], v1, s[20:23], s52 offen offset:2176 nt
    v_add_u32 v1, 0x4000, v1
    buffer_load_dwordx4 v[112:115], v1, s[20:23], 0 offen offset:0 nt
    buffer_load_dwordx4 v[116:119], v1, s[20:23], 0 offen offset:128 nt
    buffer_load_dwordx4 v[120:123], v1, s[20:23], 0 offen offset:2048 nt
    buffer_load_dwordx4 v[124:127], v1, s[20:23], 0 offen offset:2176 nt
    buffer_load_dwordx4 v[128:131], v1, s[20:23], s52 offen offset:0 nt
    buffer_load_dwordx4 v[132:135], v1, s[20:23], s52 offen offset:128 nt
    buffer_load_dwordx4 v[136:139], v1, s[20:23], s52 offen offset:2048 nt
    buffer_load_dwordx4 v[140:143], v1, s[20:23], s52 offen offset:2176 nt
    v_add_u32 v1, 0x4000, v1
    buffer_load_dwordx4 v[144:147], v1, s[20:23], 0 offen offset:0 nt
    buffer_load_dwordx4 v[148:151], v1, s[20:23], 0 offen offset:128 nt
    buffer_load_dwordx4 v[152:155], v1, s[20:23], 0 offen offset:2048 nt
    buffer_load_dwordx4 v[156:159], v1, s[20:23], 0 offen offset:2176 nt
    buffer_load_dwordx4 v[160:163], v1, s[20:23], s52 offen offset:0 nt
    buffer_load_dwordx4 v[164:167], v1, s[20:23], s52 offen offset:128 nt
    buffer_load_dwordx4 v[168:171], v1, s[20:23], s52 offen offset:2048 nt
    buffer_load_dwordx4 v[172:175], v1, s[20:23], s52 offen offset:2176 nt
    v_add_u32 v1, 0x4000, v1
    buffer_load_dwordx4 v[176:179], v1, s[20:23], 0 offen offset:0 nt
    buffer_load_dwordx4 v[180:183], v1, s[20:23], 0 offen offset:128 nt
    buffer_load_dwordx4 v[184:187], v1, s[20:23], 0 offen offset:2048 nt
    buffer_load_dwordx4 v[188:191], v1, s[20:23], 0 offen offset:2176 nt
    buffer_load_dwordx4 v[192:195], v1, s[20:23], s52 offen offset:0 nt
    buffer_load_dwordx4 v[196:199], v1, s[20:23], s52 offen offset:128 nt
    buffer_load_dwordx4 v[200:203], v1, s[20:23], s52 offen offset:2048 nt
    buffer_load_dwordx4 v[204:207], v1, s[20:23], s52 offen offset:2176 nt
    v_add_u32 v1, 0x4000, v1
    s_mov_b32 s51, 12
    s_mov_b32 s92, 0x1c000
L1_sj:
    s_getreg_b32 s90, hwreg(HW_REG_XCC_ID, 0, 3)
    s_lshl_b32 s87, s90, 12
    s_add_u32 s87, s87, 0x80000
    s_add_u32 s88, s18, s87
    s_addc_u32 s89, s19, 0
    s_lshr_b32 s93, s2, 3
    s_lshl_b32 s93, s93, 1
    s_add_u32 s93, s93, s59
    s_lshl_b64 s[94:95], 1, s93
    v_lshlrev_b32 v253, 2, v0
    v_mov_b32 v254, 0
    v_mov_b32 v252, 0
    s_mov_b64 exec, s[94:95]
    global_store_dword v253, v254, s[88:89]
    s_mov_b64 exec, -1
    s_lshl_b32 s91, s90, 3
    s_mov_b32 s86, 0xfb04fb05
    s_mov_b32 s87, 0xfb04fe05
    s_lshr_b64 s[86:87], s[86:87], s91
    s_sext_i32_i8 s86, s86
    s_add_u32 s24, s8, s53
    s_addc_u32 s25, s9, 0
    s_mov_b32 s26, 0x880000
    s_mov_b32 s27, 0x20000
    s_mov_b32 s50, 16
    v_and_b32 v7, 7, v0
    v_lshrrev_b32 v8, 5, v0
    v_lshl_add_u32 v8, v8, 4, v7
    v_mul_u32_u24 v8, 784, v8
    v_bfe_u32 v11, v0, 3, 2
    v_lshl_add_u32 v11, v11, 2, v8
    v_lshl_add_u32 v209, v10, 3, v7
    v_lshlrev_b32 v209, 4, v209
    v_and_b32 v8, 8, v0
    v_add3_u32 v209, v209, v8, s56
    s_lshl_b32 s54, s59, 11
    v_lshlrev_b32 v210, 2, v7
    v_add_u32 v210, s54, v210
    s_barrier
    v_mov_b32 v5, 0
    v_mov_b32 v247, s59
    v_lshlrev_b32 v247, 2, v247
    ds_write_b32 v247, v5 offset:41728
L1_kreset:
    ds_read2_b32 v[48:49], v11 offset0:0 offset1:96
    ds_read2_b32 v[64:65], v11 offset0:32 offset1:128
    ds_read2_b32 v[224:225], v11 offset0:64 offset1:160
    ds_read2_b32 v[50:51], v11 offset0:4 offset1:100
    ds_read2_b32 v[66:67], v11 offset0:36 offset1:132
    ds_read2_b32 v[226:227], v11 offset0:68 offset1:164
    ds_read2_b32 v[52:53], v11 offset0:8 offset1:104
    ds_read2_b32 v[68:69], v11 offset0:40 offset1:136
    ds_read2_b32 v[228:229], v11 offset0:72 offset1:168
    ds_read2_b32 v[54:55], v11 offset0:12 offset1:108
    ds_read2_b32 v[70:71], v11 offset0:44 offset1:140
    ds_read2_b32 v[230:231], v11 offset0:76 offset1:172
    v_mov_b32 v3, 0xff800000
    v_mov_b32 v4, 0xff800000
    v_mov_b32 v5, 0
    s_waitcnt lgkmcnt(6)
    ds_read2_b32 v[56:57], v11 offset0:16 offset1:112
    ds_read2_b32 v[72:73], v11 offset0:48 offset1:144
    ds_read2_b32 v[232:233], v11 offset0:80 offset1:176
    ds_read2_b32 v[58:59], v11 offset0:20 offset1:116
    ds_read2_b32 v[74:75], v11 offset0:52 offset1:148
    ds_read2_b32 v[234:235], v11 offset0:84 offset1:180
    v_pk_add_f32 v[48:49], v[48:49], v[64:65]
    v_pk_add_f32 v[50:51], v[50:51], v[66:67]
    v_pk_add_f32 v[48:49], v[48:49], v[224:225]
    v_pk_add_f32 v[50:51], v[50:51], v[226:227]
    v_cvt_pk_bf16_f32 v40, v48, v50
    v_cvt_pk_bf16_f32 v44, v49, v51
    s_waitcnt lgkmcnt(6)
    ds_read2_b32 v[60:61], v11 offset0:24 offset1:120
    ds_read2_b32 v[76:77], v11 offset0:56 offset1:152
    ds_read2_b32 v[236:237], v11 offset0:88 offset1:184
    ds_read2_b32 v[62:63], v11 offset0:28 offset1:124
    ds_read2_b32 v[78:79], v11 offset0:60 offset1:156
    ds_read2_b32 v[238:239], v11 offset0:92 offset1:188
    v_pk_add_f32 v[52:53], v[52:53], v[68:69]
    v_pk_add_f32 v[54:55], v[54:55], v[70:71]
    v_pk_add_f32 v[52:53], v[52:53], v[228:229]
    v_pk_add_f32 v[54:55], v[54:55], v[230:231]
    v_cvt_pk_bf16_f32 v41, v52, v54
    v_cvt_pk_bf16_f32 v45, v53, v55
    s_waitcnt lgkmcnt(6)
    v_pk_add_f32 v[56:57], v[56:57], v[72:73]
    v_pk_add_f32 v[58:59], v[58:59], v[74:75]
    v_pk_add_f32 v[56:57], v[56:57], v[232:233]
    v_pk_add_f32 v[58:59], v[58:59], v[234:235]
    v_cvt_pk_bf16_f32 v42, v56, v58
    v_cvt_pk_bf16_f32 v46, v57, v59
    s_waitcnt lgkmcnt(0)
    v_pk_add_f32 v[60:61], v[60:61], v[76:77]
    v_pk_add_f32 v[62:63], v[62:63], v[78:79]
    v_pk_add_f32 v[60:61], v[60:61], v[236:237]
    v_pk_add_f32 v[62:63], v[62:63], v[238:239]
    v_cvt_pk_bf16_f32 v43, v60, v62
    v_cvt_pk_bf16_f32 v47, v61, v63
    v_add_u32 v11, 6272, v11
L1_kloop:
    s_cmp_lg_u32 s50, s51
    s_cbranch_scc1 L1_nosig
    s_barrier
L1_nosig:
    s_bitcmp1_b32 s92, s50
    s_cbranch_scc1 L1_kb1
L1_kb0:
    s_lshr_b32 s63, s63, 1
    s_and_b32 s53, s63, 3
    s_cbranch_scc0 L1_kw0k0
    s_waitcnt vmcnt(8)
    s_cmp_lg_u32 s53, 3
    s_cbranch_scc1 L1_kw0k0
    s_waitcnt vmcnt(0)
L1_kw0k0:
    s_bitcmp1_b32 s63, 2
    s_waitcnt vmcnt(16) lgkmcnt(2)
    v_mfma_f32_16x16x32_bf16 v[12:15], v[80:83], v[40:43], 0
    v_mfma_f32_16x16x32_bf16 v[16:19], v[88:91], v[40:43], 0
    v_mfma_f32_16x16x32_bf16 v[20:23], v[96:99], v[40:43], 0
    v_mfma_f32_16x16x32_bf16 v[24:27], v[104:107], v[40:43], 0
    v_mfma_f32_16x16x32_bf16 v[12:15], v[84:87], v[44:47], v[12:15]
    v_mfma_f32_16x16x32_bf16 v[16:19], v[92:95], v[44:47], v[16:19]
    v_mfma_f32_16x16x32_bf16 v[20:23], v[100:103], v[44:47], v[20:23]
    v_mfma_f32_16x16x32_bf16 v[24:27], v[108:111], v[44:47], v[24:27]
    s_cbranch_scc1 L1_alt0k0
    s_waitcnt vmcnt(11)
    buffer_load_dwordx4 v[176:179], v1, s[20:23], 0 offen offset:0 nt
    buffer_load_dwordx4 v[180:183], v1, s[20:23], 0 offen offset:128 nt
    s_waitcnt vmcnt(11)
    buffer_load_dwordx4 v[184:187], v1, s[20:23], 0 offen offset:2048 nt
    buffer_load_dwordx4 v[188:191], v1, s[20:23], 0 offen offset:2176 nt
    s_waitcnt vmcnt(11)
    buffer_load_dwordx4 v[192:195], v1, s[20:23], s52 offen offset:0 nt
    buffer_load_dwordx4 v[196:199], v1, s[20:23], s52 offen offset:128 nt
    s_waitcnt vmcnt(11)
    buffer_load_dwordx4 v[200:203], v1, s[20:23], s52 offen offset:2048 nt
    buffer_load_dwordx4 v[204:207], v1, s[20:23], s52 offen offset:2176 nt
    v_add_u32 v1, 0x4000, v1
L1_kret0k0:
    v_add_f32_dpp v12, v13, v12 row_ror:8 row_mask:0xf bank_mask:0x3
    v_add_f32_dpp v14, v15, v14 row_ror:8 row_mask:0xf bank_mask:0x3
    v_add_f32_dpp v16, v17, v16 row_ror:8 row_mask:0xf bank_mask:0x3
    v_add_f32_dpp v18, v19, v18 row_ror:8 row_mask:0xf bank_mask:0x3
    v_add_f32_dpp v12, v20, v21 row_ror:8 row_mask:0xf bank_mask:0xc
    v_add_f32_dpp v14, v22, v23 row_ror:8 row_mask:0xf bank_mask:0xc
    v_add_f32_dpp v16, v24, v25 row_ror:8 row_mask:0xf bank_mask:0xc
    v_add_f32_dpp v18, v26, v27 row_ror:8 row_mask:0xf bank_mask:0xc
    v_max3_f32 v7, v12, v14, v3
    v_max3_f32 v7, v7, v16, v18
    s_nop 1
    v_max_f32_dpp v7, v7, v7 row_ror:8 row_mask:0xf bank_mask:0xf
    v_mov_b32 v8, v7
    s_nop 1
    v_permlane16_swap_b32 v7, v8
    s_nop 0
    v_max_f32 v7, v7, v8
    v_mov_b32 v8, v7
    s_nop 1
    v_permlane32_swap_b32 v7, v8
    s_nop 0
    v_max_f32 v3, v7, v8
    v_mul_f32 v7, s46, v3
    v_sub_f32 v6, v4, v7
    v_fma_f32 v12, v12, s46, -v7
    v_fma_f32 v14, v14, s46, -v7
    v_fma_f32 v16, v16, s46, -v7
    v_fma_f32 v18, v18, s46, -v7
    v_exp_f32 v6, v6
    v_exp_f32 v12, v12
    v_exp_f32 v14, v14
    v_exp_f32 v16, v16
    v_exp_f32 v18, v18
    v_mov_b32 v4, v7
    v_cmp_neq_f32 vcc, 1.0, v6
    ds_write_b32 v210, v6 offset:46080
    v_cvt_pk_bf16_f32 v212, v12, v14
    v_cvt_pk_bf16_f32 v213, v16, v18
    v_fma_f32 v5, v5, v6, v12
    ds_write_b64 v209, v[212:213] offset:50176
    v_add_f32 v8, v14, v16
    v_add_f32 v5, v5, v18
    s_cmp_lg_u64 vcc, 0
    v_add_f32 v5, v5, v8
    s_addc_u32 s80, s80, s80
    s_lshr_b32 s63, s63, 1
    s_and_b32 s53, s63, 3
    s_cbranch_scc0 L1_kw1k0
    s_waitcnt vmcnt(8)
    s_cmp_lg_u32 s53, 3
    s_cbranch_scc1 L1_kw1k0
    s_waitcnt vmcnt(0)
L1_kw1k0:
    s_cmp_eq_u32 s50, 9
    s_cselect_b32 s53, 0x780000, 0
    v_add_u32 v1, s53, v1
    s_bitcmp1_b32 s63, 2
    s_waitcnt vmcnt(16) lgkmcnt(2)
    v_mfma_f32_16x16x32_bf16 v[12:15], v[112:115], v[40:43], 0
    v_mfma_f32_16x16x32_bf16 v[16:19], v[120:123], v[40:43], 0
    v_mfma_f32_16x16x32_bf16 v[20:23], v[128:131], v[40:43], 0
    v_mfma_f32_16x16x32_bf16 v[24:27], v[136:139], v[40:43], 0
    v_mfma_f32_16x16x32_bf16 v[12:15], v[116:119], v[44:47], v[12:15]
    v_mfma_f32_16x16x32_bf16 v[16:19], v[124:127], v[44:47], v[16:19]
    v_mfma_f32_16x16x32_bf16 v[20:23], v[132:135], v[44:47], v[20:23]
    v_mfma_f32_16x16x32_bf16 v[24:27], v[140:143], v[44:47], v[24:27]
    s_cbranch_scc1 L1_alt1k0
    s_cmp_eq_u32 s50, 1
    s_cbranch_scc1 L1_kv1k0
    s_waitcnt vmcnt(11)
    buffer_load_dwordx4 v[80:83], v1, s[20:23], 0 offen offset:0 nt
    buffer_load_dwordx4 v[84:87], v1, s[20:23], 0 offen offset:128 nt
    s_waitcnt vmcnt(11)
    buffer_load_dwordx4 v[88:91], v1, s[20:23], 0 offen offset:2048 nt
    buffer_load_dwordx4 v[92:95], v1, s[20:23], 0 offen offset:2176 nt
    s_waitcnt vmcnt(11)
    buffer_load_dwordx4 v[96:99], v1, s[20:23], s52 offen offset:0 nt
    buffer_load_dwordx4 v[100:103], v1, s[20:23], s52 offen offset:128 nt
    s_waitcnt vmcnt(11)
    buffer_load_dwordx4 v[104:107], v1, s[20:23], s52 offen offset:2048 nt
    buffer_load_dwordx4 v[108:111], v1, s[20:23], s52 offen offset:2176 nt
    v_add_u32 v1, 0x4000, v1
L1_kret1k0:
    v_add_f32_dpp v12, v13, v12 row_ror:8 row_mask:0xf bank_mask:0x3
    v_add_f32_dpp v14, v15, v14 row_ror:8 row_mask:0xf bank_mask:0x3
    v_add_f32_dpp v16, v17, v16 row_ror:8 row_mask:0xf bank_mask:0x3
    v_add_f32_dpp v18, v19, v18 row_ror:8 row_mask:0xf bank_mask:0x3
    v_add_f32_dpp v12, v20, v21 row_ror:8 row_mask:0xf bank_mask:0xc
    v_add_f32_dpp v14, v22, v23 row_ror:8 row_mask:0xf bank_mask:0xc
    v_add_f32_dpp v16, v24, v25 row_ror:8 row_mask:0xf bank_mask:0xc
    v_add_f32_dpp v18, v26, v27 row_ror:8 row_mask:0xf bank_mask:0xc
    v_max3_f32 v7, v12, v14, v3
    v_max3_f32 v7, v7, v16, v18
    s_nop 1
    v_max_f32_dpp v7, v7, v7 row_ror:8 row_mask:0xf bank_mask:0xf
    v_mov_b32 v8, v7
    s_nop 1
    v_permlane16_swap_b32 v7, v8
    s_nop 0
    v_max_f32 v7, v7, v8
    v_mov_b32 v8, v7
    s_nop 1
    v_permlane32_swap_b32 v7, v8
    s_nop 0
    v_max_f32 v3, v7, v8
    v_mul_f32 v7, s46, v3
    v_sub_f32 v6, v4, v7
    v_fma_f32 v12, v12, s46, -v7
    v_fma_f32 v14, v14, s46, -v7
    v_fma_f32 v16, v16, s46, -v7
    v_fma_f32 v18, v18, s46, -v7
    v_exp_f32 v6, v6
    v_exp_f32 v12, v12
    v_exp_f32 v14, v14
    v_exp_f32 v16, v16
    v_exp_f32 v18, v18
    v_mov_b32 v4, v7
    v_cmp_neq_f32 vcc, 1.0, v6
    ds_write_b32 v210, v6 offset:46112
    v_cvt_pk_bf16_f32 v212, v12, v14
    v_cvt_pk_bf16_f32 v213, v16, v18
    v_fma_f32 v5, v5, v6, v12
    ds_write_b64 v209, v[212:213] offset:50688
    v_add_f32 v8, v14, v16
    v_add_f32 v5, v5, v18
    s_cmp_lg_u64 vcc, 0
    v_add_f32 v5, v5, v8
    s_addc_u32 s80, s80, s80
    s_lshr_b32 s63, s63, 1
    s_and_b32 s53, s63, 3
    s_cbranch_scc0 L1_kw2k0
    s_waitcnt vmcnt(8)
    s_cmp_lg_u32 s53, 3
    s_cbranch_scc1 L1_kw2k0
    s_waitcnt vmcnt(0)
L1_kw2k0:
    s_bitcmp1_b32 s63, 2
    s_waitcnt vmcnt(16) lgkmcnt(2)
    v_mfma_f32_16x16x32_bf16 v[12:15], v[144:147], v[40:43], 0
    v_mfma_f32_16x16x32_bf16 v[16:19], v[152:155], v[40:43], 0
    v_mfma_f32_16x16x32_bf16 v[20:23], v[160:163], v[40:43], 0
    v_mfma_f32_16x16x32_bf16 v[24:27], v[168:171], v[40:43], 0
    v_mfma_f32_16x16x32_bf16 v[12:15], v[148:151], v[44:47], v[12:15]
    v_mfma_f32_16x16x32_bf16 v[16:19], v[156:159], v[44:47], v[16:19]
    v_mfma_f32_16x16x32_bf16 v[20:23], v[164:167], v[44:47], v[20:23]
    v_mfma_f32_16x16x32_bf16 v[24:27], v[172:175], v[44:47], v[24:27]
    s_cbranch_scc1 L1_alt2k0
    s_cmp_eq_u32 s50, 1
    s_cbranch_scc1 L1_kv2k0
    s_waitcnt vmcnt(11)
    buffer_load_dwordx4 v[112:115], v1, s[20:23], 0 offen offset:0 nt
    buffer_load_dwordx4 v[116:119], v1, s[20:23], 0 offen offset:128 nt
    s_waitcnt vmcnt(11)
    buffer_load_dwordx4 v[120:123], v1, s[20:23], 0 offen offset:2048 nt
    buffer_load_dwordx4 v[124:127], v1, s[20:23], 0 offen offset:2176 nt
    s_waitcnt vmcnt(11)
    buffer_load_dwordx4 v[128:131], v1, s[20:23], s52 offen offset:0 nt
    buffer_load_dwordx4 v[132:135], v1, s[20:23], s52 offen offset:128 nt
    s_waitcnt vmcnt(11)
    buffer_load_dwordx4 v[136:139], v1, s[20:23], s52 offen offset:2048 nt
    buffer_load_dwordx4 v[140:143], v1, s[20:23], s52 offen offset:2176 nt
    v_add_u32 v1, 0x4000, v1
L1_kret2k0:
    v_add_f32_dpp v12, v13, v12 row_ror:8 row_mask:0xf bank_mask:0x3
    v_add_f32_dpp v14, v15, v14 row_ror:8 row_mask:0xf bank_mask:0x3
    v_add_f32_dpp v16, v17, v16 row_ror:8 row_mask:0xf bank_mask:0x3
    v_add_f32_dpp v18, v19, v18 row_ror:8 row_mask:0xf bank_mask:0x3
    v_add_f32_dpp v12, v20, v21 row_ror:8 row_mask:0xf bank_mask:0xc
    v_add_f32_dpp v14, v22, v23 row_ror:8 row_mask:0xf bank_mask:0xc
    v_add_f32_dpp v16, v24, v25 row_ror:8 row_mask:0xf bank_mask:0xc
    v_add_f32_dpp v18, v26, v27 row_ror:8 row_mask:0xf bank_mask:0xc
    v_max3_f32 v7, v12, v14, v3
    v_max3_f32 v7, v7, v16, v18
    s_nop 1
    v_max_f32_dpp v7, v7, v7 row_ror:8 row_mask:0xf bank_mask:0xf
    v_mov_b32 v8, v7
    s_nop 1
    v_permlane16_swap_b32 v7, v8
    s_nop 0
    v_max_f32 v7, v7, v8
    v_mov_b32 v8, v7
    s_nop 1
    v_permlane32_swap_b32 v7, v8
    s_nop 0
    v_max_f32 v3, v7, v8
    v_mul_f32 v7, s46, v3
    v_sub_f32 v6, v4, v7
    v_fma_f32 v12, v12, s46, -v7
    v_fma_f32 v14, v14, s46, -v7
    v_fma_f32 v16, v16, s46, -v7
    v_fma_f32 v18, v18, s46, -v7
    v_exp_f32 v6, v6
    v_exp_f32 v12, v12
    v_exp_f32 v14, v14
    v_exp_f32 v16, v16
    v_exp_f32 v18, v18
    v_mov_b32 v4, v7
    v_cmp_neq_f32 vcc, 1.0, v6
    ds_write_b32 v210, v6 offset:46144
    v_cvt_pk_bf16_f32 v212, v12, v14
    v_cvt_pk_bf16_f32 v213, v16, v18
    v_fma_f32 v5, v5, v6, v12
    ds_write_b64 v209, v[212:213] offset:51200
    v_add_f32 v8, v14, v16
    v_add_f32 v5, v5, v18
    s_cmp_lg_u64 vcc, 0
    v_add_f32 v5, v5, v8
    s_addc_u32 s80, s80, s80
    s_lshr_b32 s63, s63, 1
    s_and_b32 s53, s63, 3
    s_cbranch_scc0 L1_kw3k0
    s_waitcnt vmcnt(8)
    s_cmp_lg_u32 s53, 3
    s_cbranch_scc1 L1_kw3k0
    s_waitcnt vmcnt(0)
L1_kw3k0:
    s_bitcmp1_b32 s63, 2
    s_waitcnt vmcnt(16) lgkmcnt(2)
    v_mfma_f32_16x16x32_bf16 v[12:15], v[176:179], v[40:43], 0
    v_mfma_f32_16x16x32_bf16 v[16:19], v[184:187], v[40:43], 0
    v_mfma_f32_16x16x32_bf16 v[20:23], v[192:195], v[40:43], 0
    v_mfma_f32_16x16x32_bf16 v[24:27], v[200:203], v[40:43], 0
    v_mfma_f32_16x16x32_bf16 v[12:15], v[180:183], v[44:47], v[12:15]
    v_mfma_f32_16x16x32_bf16 v[16:19], v[188:191], v[44:47], v[16:19]
    v_mfma_f32_16x16x32_bf16 v[20:23], v[196:199], v[44:47], v[20:23]
    v_mfma_f32_16x16x32_bf16 v[24:27], v[204:207], v[44:47], v[24:27]
    s_cbranch_scc1 L1_alt3k0
    s_cmp_eq_u32 s50, 1
    s_cbranch_scc1 L1_kv3k0
    s_waitcnt vmcnt(11)
    buffer_load_dwordx4 v[144:147], v1, s[20:23], 0 offen offset:0 nt
    buffer_load_dwordx4 v[148:151], v1, s[20:23], 0 offen offset:128 nt
    s_waitcnt vmcnt(11)
    buffer_load_dwordx4 v[152:155], v1, s[20:23], 0 offen offset:2048 nt
    buffer_load_dwordx4 v[156:159], v1, s[20:23], 0 offen offset:2176 nt
    s_waitcnt vmcnt(11)
    buffer_load_dwordx4 v[160:163], v1, s[20:23], s52 offen offset:0 nt
    buffer_load_dwordx4 v[164:167], v1, s[20:23], s52 offen offset:128 nt
    s_waitcnt vmcnt(11)
    buffer_load_dwordx4 v[168:171], v1, s[20:23], s52 offen offset:2048 nt
    buffer_load_dwordx4 v[172:175], v1, s[20:23], s52 offen offset:2176 nt
    v_add_u32 v1, 0x4000, v1
L1_kret3k0:
    v_add_f32_dpp v12, v13, v12 row_ror:8 row_mask:0xf bank_mask:0x3
    v_add_f32_dpp v14, v15, v14 row_ror:8 row_mask:0xf bank_mask:0x3
    v_add_f32_dpp v16, v17, v16 row_ror:8 row_mask:0xf bank_mask:0x3
    v_add_f32_dpp v18, v19, v18 row_ror:8 row_mask:0xf bank_mask:0x3
    v_add_f32_dpp v12, v20, v21 row_ror:8 row_mask:0xf bank_mask:0xc
    v_add_f32_dpp v14, v22, v23 row_ror:8 row_mask:0xf bank_mask:0xc
    v_add_f32_dpp v16, v24, v25 row_ror:8 row_mask:0xf bank_mask:0xc
    v_add_f32_dpp v18, v26, v27 row_ror:8 row_mask:0xf bank_mask:0xc
    v_max3_f32 v7, v12, v14, v3
    v_max3_f32 v7, v7, v16, v18
    s_nop 1
    v_max_f32_dpp v7, v7, v7 row_ror:8 row_mask:0xf bank_mask:0xf
    v_mov_b32 v8, v7
    s_nop 1
    v_permlane16_swap_b32 v7, v8
    s_nop 0
    v_max_f32 v7, v7, v8
    v_mov_b32 v8, v7
    s_nop 1
    v_permlane32_swap_b32 v7, v8
    s_nop 0
    v_max_f32 v3, v7, v8
    v_mul_f32 v7, s46, v3
    v_sub_f32 v6, v4, v7
    v_fma_f32 v12, v12, s46, -v7
    v_fma_f32 v14, v14, s46, -v7
    v_fma_f32 v16, v16, s46, -v7
    v_fma_f32 v18, v18, s46, -v7
    v_exp_f32 v6, v6
    v_exp_f32 v12, v12
    v_exp_f32 v14, v14
    v_exp_f32 v16, v16
    v_exp_f32 v18, v18
    v_mov_b32 v4, v7
    v_cmp_neq_f32 vcc, 1.0, v6
    ds_write_b32 v210, v6 offset:46176
    v_cvt_pk_bf16_f32 v212, v12, v14
    v_cvt_pk_bf16_f32 v213, v16, v18
    v_fma_f32 v5, v5, v6, v12
    ds_write_b64 v209, v[212:213] offset:51712
    v_add_f32 v8, v14, v16
    v_add_f32 v5, v5, v18
    s_cmp_lg_u64 vcc, 0
    v_add_f32 v5, v5, v8
    s_addc_u32 s80, s80, s80
    s_branch L1_kj
L1_kb1:
    s_lshr_b32 s63, s63, 1
    s_bitcmp1_b32 s63, 2
    s_cbranch_scc1 L1_kh0k1
    s_cmp_eq_u32 s50, 16
    s_cbranch_scc1 L1_kh0k1
    buffer_load_dwordx4 v[176:179], v1, s[20:23], 0 offen offset:0 nt
    buffer_load_dwordx4 v[180:183], v1, s[20:23], 0 offen offset:128 nt
    buffer_load_dwordx4 v[184:187], v1, s[20:23], 0 offen offset:2048 nt
    buffer_load_dwordx4 v[188:191], v1, s[20:23], 0 offen offset:2176 nt
    buffer_load_dwordx4 v[192:195], v1, s[20:23], s52 offen offset:0 nt
    buffer_load_dwordx4 v[196:199], v1, s[20:23], s52 offen offset:128 nt
    buffer_load_dwordx4 v[200:203], v1, s[20:23], s52 offen offset:2048 nt
    buffer_load_dwordx4 v[204:207], v1, s[20:23], s52 offen offset:2176 nt
    v_add_u32 v1, 0x4000, v1
L1_kh0k1:
    s_and_b32 s53, s63, 7
    s_cbranch_scc0 L1_kw0k1
    s_bcnt1_i32_b32 s53, s53
    s_waitcnt vmcnt(16)
    s_cmp_lt_u32 s53, 2
    s_cbranch_scc1 L1_kw0k1
    s_waitcnt vmcnt(8)
    s_cmp_lt_u32 s53, 3
    s_cbranch_scc1 L1_kw0k1
    s_waitcnt vmcnt(0)
L1_kw0k1:
    s_bitcmp1_b32 s63, 2
    s_waitcnt vmcnt(24) lgkmcnt(2)
    v_mfma_f32_16x16x32_bf16 v[12:15], v[80:83], v[40:43], 0
    v_mfma_f32_16x16x32_bf16 v[16:19], v[88:91], v[40:43], 0
    v_mfma_f32_16x16x32_bf16 v[20:23], v[96:99], v[40:43], 0
    v_mfma_f32_16x16x32_bf16 v[24:27], v[104:107], v[40:43], 0
    v_mfma_f32_16x16x32_bf16 v[12:15], v[84:87], v[44:47], v[12:15]
    v_mfma_f32_16x16x32_bf16 v[16:19], v[92:95], v[44:47], v[16:19]
    v_mfma_f32_16x16x32_bf16 v[20:23], v[100:103], v[44:47], v[20:23]
    v_mfma_f32_16x16x32_bf16 v[24:27], v[108:111], v[44:47], v[24:27]
    s_cbranch_scc1 L1_alt0k1
    s_nop 3
L1_kret0k1:
    v_add_f32_dpp v12, v13, v12 row_ror:8 row_mask:0xf bank_mask:0x3
    v_add_f32_dpp v14, v15, v14 row_ror:8 row_mask:0xf bank_mask:0x3
    v_add_f32_dpp v16, v17, v16 row_ror:8 row_mask:0xf bank_mask:0x3
    v_add_f32_dpp v18, v19, v18 row_ror:8 row_mask:0xf bank_mask:0x3
    v_add_f32_dpp v12, v20, v21 row_ror:8 row_mask:0xf bank_mask:0xc
    v_add_f32_dpp v14, v22, v23 row_ror:8 row_mask:0xf bank_mask:0xc
    v_add_f32_dpp v16, v24, v25 row_ror:8 row_mask:0xf bank_mask:0xc
    v_add_f32_dpp v18, v26, v27 row_ror:8 row_mask:0xf bank_mask:0xc
    v_max3_f32 v7, v12, v14, v3
    v_max3_f32 v7, v7, v16, v18
    s_nop 1
    v_max_f32_dpp v7, v7, v7 row_ror:8 row_mask:0xf bank_mask:0xf
    v_mov_b32 v8, v7
    s_nop 1
    v_permlane16_swap_b32 v7, v8
    s_nop 0
    v_max_f32 v7, v7, v8
    v_mov_b32 v8, v7
    s_nop 1
    v_permlane32_swap_b32 v7, v8
    s_nop 0
    v_max_f32 v3, v7, v8
    v_mul_f32 v7, s46, v3
    v_sub_f32 v6, v4, v7
    v_fma_f32 v12, v12, s46, -v7
    v_fma_f32 v14, v14, s46, -v7
    v_fma_f32 v16, v16, s46, -v7
    v_fma_f32 v18, v18, s46, -v7
    v_exp_f32 v6, v6
    v_exp_f32 v12, v12
    v_exp_f32 v14, v14
    v_exp_f32 v16, v16
    v_exp_f32 v18, v18
    v_mov_b32 v4, v7
    v_cmp_neq_f32 vcc, 1.0, v6
    ds_write_b32 v210, v6 offset:46080
    v_cvt_pk_bf16_f32 v212, v12, v14
    v_cvt_pk_bf16_f32 v213, v16, v18
    v_fma_f32 v5, v5, v6, v12
    ds_write_b64 v209, v[212:213] offset:50176
    v_add_f32 v8, v14, v16
    v_add_f32 v5, v5, v18
    s_cmp_lg_u64 vcc, 0
    v_add_f32 v5, v5, v8
    s_addc_u32 s80, s80, s80
    s_lshr_b32 s63, s63, 1
    s_cmp_eq_u32 s50, 9
    s_cselect_b32 s53, 0x780000, 0
    v_add_u32 v1, s53, v1
    s_bitcmp1_b32 s63, 2
    s_cbranch_scc1 L1_kh1k1
    buffer_load_dwordx4 v[80:83], v1, s[20:23], 0 offen offset:0 nt
    buffer_load_dwordx4 v[84:87], v1, s[20:23], 0 offen offset:128 nt
    buffer_load_dwordx4 v[88:91], v1, s[20:23], 0 offen offset:2048 nt
    buffer_load_dwordx4 v[92:95], v1, s[20:23], 0 offen offset:2176 nt
    buffer_load_dwordx4 v[96:99], v1, s[20:23], s52 offen offset:0 nt
    buffer_load_dwordx4 v[100:103], v1, s[20:23], s52 offen offset:128 nt
    buffer_load_dwordx4 v[104:107], v1, s[20:23], s52 offen offset:2048 nt
    buffer_load_dwordx4 v[108:111], v1, s[20:23], s52 offen offset:2176 nt
    v_add_u32 v1, 0x4000, v1
L1_kh1k1:
    s_and_b32 s53, s63, 7
    s_cbranch_scc0 L1_kw1k1
    s_bcnt1_i32_b32 s53, s53
    s_waitcnt vmcnt(16)
    s_cmp_lt_u32 s53, 2
    s_cbranch_scc1 L1_kw1k1
    s_waitcnt vmcnt(8)
    s_cmp_lt_u32 s53, 3
    s_cbranch_scc1 L1_kw1k1
    s_waitcnt vmcnt(0)
L1_kw1k1:
    s_bitcmp1_b32 s63, 2
    s_waitcnt vmcnt(24) lgkmcnt(2)
    v_mfma_f32_16x16x32_bf16 v[12:15], v[112:115], v[40:43], 0
    v_mfma_f32_16x16x32_bf16 v[16:19], v[120:123], v[40:43], 0
    v_mfma_f32_16x16x32_bf16 v[20:23], v[128:131], v[40:43], 0
    v_mfma_f32_16x16x32_bf16 v[24:27], v[136:139], v[40:43], 0
    v_mfma_f32_16x16x32_bf16 v[12:15], v[116:119], v[44:47], v[12:15]
    v_mfma_f32_16x16x32_bf16 v[16:19], v[124:127], v[44:47], v[16:19]
    v_mfma_f32_16x16x32_bf16 v[20:23], v[132:135], v[44:47], v[20:23]
    v_mfma_f32_16x16x32_bf16 v[24:27], v[140:143], v[44:47], v[24:27]
    s_cbranch_scc1 L1_alt1k1
    s_nop 3
L1_kret1k1:
    v_add_f32_dpp v12, v13, v12 row_ror:8 row_mask:0xf bank_mask:0x3
    v_add_f32_dpp v14, v15, v14 row_ror:8 row_mask:0xf bank_mask:0x3
    v_add_f32_dpp v16, v17, v16 row_ror:8 row_mask:0xf bank_mask:0x3
    v_add_f32_dpp v18, v19, v18 row_ror:8 row_mask:0xf bank_mask:0x3
    v_add_f32_dpp v12, v20, v21 row_ror:8 row_mask:0xf bank_mask:0xc
    v_add_f32_dpp v14, v22, v23 row_ror:8 row_mask:0xf bank_mask:0xc
    v_add_f32_dpp v16, v24, v25 row_ror:8 row_mask:0xf bank_mask:0xc
    v_add_f32_dpp v18, v26, v27 row_ror:8 row_mask:0xf bank_mask:0xc
    v_max3_f32 v7, v12, v14, v3
    v_max3_f32 v7, v7, v16, v18
    s_nop 1
    v_max_f32_dpp v7, v7, v7 row_ror:8 row_mask:0xf bank_mask:0xf
    v_mov_b32 v8, v7
    s_nop 1
    v_permlane16_swap_b32 v7, v8
    s_nop 0
    v_max_f32 v7, v7, v8
    v_mov_b32 v8, v7
    s_nop 1
    v_permlane32_swap_b32 v7, v8
    s_nop 0
    v_max_f32 v3, v7, v8
    v_mul_f32 v7, s46, v3
    v_sub_f32 v6, v4, v7
    v_fma_f32 v12, v12, s46, -v7
    v_fma_f32 v14, v14, s46, -v7
    v_fma_f32 v16, v16, s46, -v7
    v_fma_f32 v18, v18, s46, -v7
    v_exp_f32 v6, v6
    v_exp_f32 v12, v12
    v_exp_f32 v14, v14
    v_exp_f32 v16, v16
    v_exp_f32 v18, v18
    v_mov_b32 v4, v7
    v_cmp_neq_f32 vcc, 1.0, v6
    ds_write_b32 v210, v6 offset:46112
    v_cvt_pk_bf16_f32 v212, v12, v14
    v_cvt_pk_bf16_f32 v213, v16, v18
    v_fma_f32 v5, v5, v6, v12
    ds_write_b64 v209, v[212:213] offset:50688
    v_add_f32 v8, v14, v16
    v_add_f32 v5, v5, v18
    s_cmp_lg_u64 vcc, 0
    v_add_f32 v5, v5, v8
    s_addc_u32 s80, s80, s80
    s_lshr_b32 s63, s63, 1
    s_bitcmp1_b32 s63, 2
    s_cbranch_scc1 L1_kh2k1
    buffer_load_dwordx4 v[112:115], v1, s[20:23], 0 offen offset:0 nt
    buffer_load_dwordx4 v[116:119], v1, s[20:23], 0 offen offset:128 nt
    buffer_load_dwordx4 v[120:123], v1, s[20:23], 0 offen offset:2048 nt
    buffer_load_dwordx4 v[124:127], v1, s[20:23], 0 offen offset:2176 nt
    buffer_load_dwordx4 v[128:131], v1, s[20:23], s52 offen offset:0 nt
    buffer_load_dwordx4 v[132:135], v1, s[20:23], s52 offen offset:128 nt
    buffer_load_dwordx4 v[136:139], v1, s[20:23], s52 offen offset:2048 nt
    buffer_load_dwordx4 v[140:143], v1, s[20:23], s52 offen offset:2176 nt
    v_add_u32 v1, 0x4000, v1
L1_kh2k1:
    s_and_b32 s53, s63, 7
    s_cbranch_scc0 L1_kw2k1
    s_bcnt1_i32_b32 s53, s53
    s_waitcnt vmcnt(16)
    s_cmp_lt_u32 s53, 2
    s_cbranch_scc1 L1_kw2k1
    s_waitcnt vmcnt(8)
    s_cmp_lt_u32 s53, 3
    s_cbranch_scc1 L1_kw2k1
    s_waitcnt vmcnt(0)
L1_kw2k1:
    s_bitcmp1_b32 s63, 2
    s_waitcnt vmcnt(24) lgkmcnt(2)
    v_mfma_f32_16x16x32_bf16 v[12:15], v[144:147], v[40:43], 0
    v_mfma_f32_16x16x32_bf16 v[16:19], v[152:155], v[40:43], 0
    v_mfma_f32_16x16x32_bf16 v[20:23], v[160:163], v[40:43], 0
    v_mfma_f32_16x16x32_bf16 v[24:27], v[168:171], v[40:43], 0
    v_mfma_f32_16x16x32_bf16 v[12:15], v[148:151], v[44:47], v[12:15]
    v_mfma_f32_16x16x32_bf16 v[16:19], v[156:159], v[44:47], v[16:19]
    v_mfma_f32_16x16x32_bf16 v[20:23], v[164:167], v[44:47], v[20:23]
    v_mfma_f32_16x16x32_bf16 v[24:27], v[172:175], v[44:47], v[24:27]
    s_cbranch_scc1 L1_alt2k1
    s_nop 3
L1_kret2k1:
    v_add_f32_dpp v12, v13, v12 row_ror:8 row_mask:0xf bank_mask:0x3
    v_add_f32_dpp v14, v15, v14 row_ror:8 row_mask:0xf bank_mask:0x3
    v_add_f32_dpp v16, v17, v16 row_ror:8 row_mask:0xf bank_mask:0x3
    v_add_f32_dpp v18, v19, v18 row_ror:8 row_mask:0xf bank_mask:0x3
    v_add_f32_dpp v12, v20, v21 row_ror:8 row_mask:0xf bank_mask:0xc
    v_add_f32_dpp v14, v22, v23 row_ror:8 row_mask:0xf bank_mask:0xc
    v_add_f32_dpp v16, v24, v25 row_ror:8 row_mask:0xf bank_mask:0xc
    v_add_f32_dpp v18, v26, v27 row_ror:8 row_mask:0xf bank_mask:0xc
    v_max3_f32 v7, v12, v14, v3
    v_max3_f32 v7, v7, v16, v18
    s_nop 1
    v_max_f32_dpp v7, v7, v7 row_ror:8 row_mask:0xf bank_mask:0xf
    v_mov_b32 v8, v7
    s_nop 1
    v_permlane16_swap_b32 v7, v8
    s_nop 0
    v_max_f32 v7, v7, v8
    v_mov_b32 v8, v7
    s_nop 1
    v_permlane32_swap_b32 v7, v8
    s_nop 0
    v_max_f32 v3, v7, v8
    v_mul_f32 v7, s46, v3
    v_sub_f32 v6, v4, v7
    v_fma_f32 v12, v12, s46, -v7
    v_fma_f32 v14, v14, s46, -v7
    v_fma_f32 v16, v16, s46, -v7
    v_fma_f32 v18, v18, s46, -v7
    v_exp_f32 v6, v6
    v_exp_f32 v12, v12
    v_exp_f32 v14, v14
    v_exp_f32 v16, v16
    v_exp_f32 v18, v18
    v_mov_b32 v4, v7
    v_cmp_neq_f32 vcc, 1.0, v6
    ds_write_b32 v210, v6 offset:46144
    v_cvt_pk_bf16_f32 v212, v12, v14
    v_cvt_pk_bf16_f32 v213, v16, v18
    v_fma_f32 v5, v5, v6, v12
    ds_write_b64 v209, v[212:213] offset:51200
    v_add_f32 v8, v14, v16
    v_add_f32 v5, v5, v18
    s_cmp_lg_u64 vcc, 0
    v_add_f32 v5, v5, v8
    s_addc_u32 s80, s80, s80
    s_lshr_b32 s63, s63, 1
    s_bitcmp1_b32 s63, 2
    s_cbranch_scc1 L1_kh3k1
    buffer_load_dwordx4 v[144:147], v1, s[20:23], 0 offen offset:0 nt
    buffer_load_dwordx4 v[148:151], v1, s[20:23], 0 offen offset:128 nt
    buffer_load_dwordx4 v[152:155], v1, s[20:23], 0 offen offset:2048 nt
    buffer_load_dwordx4 v[156:159], v1, s[20:23], 0 offen offset:2176 nt
    buffer_load_dwordx4 v[160:163], v1, s[20:23], s52 offen offset:0 nt
    buffer_load_dwordx4 v[164:167], v1, s[20:23], s52 offen offset:128 nt
    buffer_load_dwordx4 v[168:171], v1, s[20:23], s52 offen offset:2048 nt
    buffer_load_dwordx4 v[172:175], v1, s[20:23], s52 offen offset:2176 nt
    v_add_u32 v1, 0x4000, v1
L1_kh3k1:
    s_and_b32 s53, s63, 7
    s_cbranch_scc0 L1_kw3k1
    s_bcnt1_i32_b32 s53, s53
    s_waitcnt vmcnt(16)
    s_cmp_lt_u32 s53, 2
    s_cbranch_scc1 L1_kw3k1
    s_waitcnt vmcnt(8)
    s_cmp_lt_u32 s53, 3
    s_cbranch_scc1 L1_kw3k1
    s_waitcnt vmcnt(0)
L1_kw3k1:
    s_bitcmp1_b32 s63, 2
    s_waitcnt vmcnt(24) lgkmcnt(2)
    v_mfma_f32_16x16x32_bf16 v[12:15], v[176:179], v[40:43], 0
    v_mfma_f32_16x16x32_bf16 v[16:19], v[184:187], v[40:43], 0
    v_mfma_f32_16x16x32_bf16 v[20:23], v[192:195], v[40:43], 0
    v_mfma_f32_16x16x32_bf16 v[24:27], v[200:203], v[40:43], 0
    v_mfma_f32_16x16x32_bf16 v[12:15], v[180:183], v[44:47], v[12:15]
    v_mfma_f32_16x16x32_bf16 v[16:19], v[188:191], v[44:47], v[16:19]
    v_mfma_f32_16x16x32_bf16 v[20:23], v[196:199], v[44:47], v[20:23]
    v_mfma_f32_16x16x32_bf16 v[24:27], v[204:207], v[44:47], v[24:27]
    s_cbranch_scc1 L1_alt3k1
    s_nop 3
L1_kret3k1:
    v_add_f32_dpp v12, v13, v12 row_ror:8 row_mask:0xf bank_mask:0x3
    v_add_f32_dpp v14, v15, v14 row_ror:8 row_mask:0xf bank_mask:0x3
    v_add_f32_dpp v16, v17, v16 row_ror:8 row_mask:0xf bank_mask:0x3
    v_add_f32_dpp v18, v19, v18 row_ror:8 row_mask:0xf bank_mask:0x3
    v_add_f32_dpp v12, v20, v21 row_ror:8 row_mask:0xf bank_mask:0xc
    v_add_f32_dpp v14, v22, v23 row_ror:8 row_mask:0xf bank_mask:0xc
    v_add_f32_dpp v16, v24, v25 row_ror:8 row_mask:0xf bank_mask:0xc
    v_add_f32_dpp v18, v26, v27 row_ror:8 row_mask:0xf bank_mask:0xc
    v_max3_f32 v7, v12, v14, v3
    v_max3_f32 v7, v7, v16, v18
    s_nop 1
    v_max_f32_dpp v7, v7, v7 row_ror:8 row_mask:0xf bank_mask:0xf
    v_mov_b32 v8, v7
    s_nop 1
    v_permlane16_swap_b32 v7, v8
    s_nop 0
    v_max_f32 v7, v7, v8
    v_mov_b32 v8, v7
    s_nop 1
    v_permlane32_swap_b32 v7, v8
    s_nop 0
    v_max_f32 v3, v7, v8
    v_mul_f32 v7, s46, v3
    v_sub_f32 v6, v4, v7
    v_fma_f32 v12, v12, s46, -v7
    v_fma_f32 v14, v14, s46, -v7
    v_fma_f32 v16, v16, s46, -v7
    v_fma_f32 v18, v18, s46, -v7
    v_exp_f32 v6, v6
    v_exp_f32 v12, v12
    v_exp_f32 v14, v14
    v_exp_f32 v16, v16
    v_exp_f32 v18, v18
    v_mov_b32 v4, v7
    v_cmp_neq_f32 vcc, 1.0, v6
    ds_write_b32 v210, v6 offset:46176
    v_cvt_pk_bf16_f32 v212, v12, v14
    v_cvt_pk_bf16_f32 v213, v16, v18
    v_fma_f32 v5, v5, v6, v12
    ds_write_b64 v209, v[212:213] offset:51712
    v_add_f32 v8, v14, v16
    v_add_f32 v5, v5, v18
    s_cmp_lg_u64 vcc, 0
    v_add_f32 v5, v5, v8
    s_addc_u32 s80, s80, s80
L1_kj:
    v_add_u32 v209, 2048, v209
    v_add_u32 v210, 128, v210
    s_sub_u32 s50, s50, 1
    s_and_b32 s53, s50, 7
    s_cbranch_scc1 L1_kloop
    v_add_f32_dpp v5, v5, v5 row_ror:8 row_mask:0xf bank_mask:0xf
    s_lshr_b32 s53, s50, 2
    v_mov_b32 v8, v5
    s_sub_u32 s53, 2, s53
    s_add_u32 s53, s53, s59
    v_permlane16_swap_b32 v5, v8
    s_lshl_b32 s53, s53, 6
    v_add_f32 v5, v5, v8
    v_mov_b32 v8, v5
    v_and_b32 v7, 7, v0
    v_lshlrev_b32 v7, 3, v7
    v_permlane32_swap_b32 v5, v8
    v_add_u32 v7, s53, v7
    v_add_f32 v5, v5, v8
    s_mov_b32 s81, s82
    s_mov_b32 s82, s80
    ds_write_b64 v7, v[4:5] offset:41472
    s_cmp_lg_u32 s50, 0
    s_waitcnt lgkmcnt(0)
    s_cbranch_scc1 L1_kreset
    v_mov_b32 v5, 1
    ds_write_b32 v247, v5 offset:41728
    v_xor_b32 v247, 4, v247
    v_and_b32 v8, 8, v0
    v_sub_u32 v209, v209, v8
    v_subrev_u32 v209, -17408, v209
    v_subrev_u32 v210, 2048, v210
    s_mov_b32 s50, 16
    ds_read_b128 v[212:215], v209
    ds_read_b32 v220, v210 offset:46080
    s_mov_b32 s60, 0x00ff00ff
    s_mov_b32 s61, s60
    s_lshl_b32 s53, s49, 4
    s_add_u32 s53, s53, s48
    s_mul_i32 s53, s53, 9216
    s_add_u32 s53, s53, 1048576
    s_add_u32 s40, s18, s53
    s_addc_u32 s41, s19, 0
    s_mov_b32 s42, 9216
    s_mov_b32 s43, 0x20000
    s_mul_i32 s37, s59, 1536
    s_add_u32 s37, s37, 768
    s_add_u32 s36, s37, 6144
L1_vreset:
    v_mov_b32 v48, 0
    v_mov_b32 v49, 0
    v_mov_b32 v50, 0
    v_mov_b32 v51, 0
    v_mov_b32 v52, 0
    v_mov_b32 v53, 0
    v_mov_b32 v54, 0
    v_mov_b32 v55, 0
    v_mov_b32 v56, 0
    v_mov_b32 v57, 0
    v_mov_b32 v58, 0
    v_mov_b32 v59, 0
    v_mov_b32 v60, 0
    v_mov_b32 v61, 0
    v_mov_b32 v62, 0
    v_mov_b32 v63, 0
    v_mov_b32 v64, 0
    v_mov_b32 v65, 0
    v_mov_b32 v66, 0
    v_mov_b32 v67, 0
    v_mov_b32 v68, 0
    v_mov_b32 v69, 0
    v_mov_b32 v70, 0
    v_mov_b32 v71, 0
    v_mov_b32 v72, 0
    v_mov_b32 v73, 0
    v_mov_b32 v74, 0
    v_mov_b32 v75, 0
    v_mov_b32 v76, 0
    v_mov_b32 v77, 0
    v_mov_b32 v78, 0
    v_mov_b32 v79, 0
    s_andn2_b32 s80, s81, 0x80000000
    s_mov_b32 s81, s82
L1_vloop:
    s_cmp_eq_u32 s50, 12
    s_cbranch_scc1 L1_fac
L1_facret:
    s_cmp_eq_u32 s50, 2
    s_cbranch_scc1 L1_smb
L1_smbret:
    v_cmp_ge_u32 vcc, v252, v254
    s_bcnt1_i32_b64 s87, vcc
    v_cmp_gt_u32 vcc, v252, v254
    s_bcnt1_i32_b64 s91, vcc
    s_add_u32 s87, s87, s86
    s_add_u32 s87, s87, s91
    s_bitcmp1_b32 0x10000, s50
    s_cbranch_scc1 L1_vb1
    s_bitcmp1_b32 0x2, s50
    s_cbranch_scc1 L1_vb3
    s_cmp_lt_i32 s87, 22
    s_cbranch_scc1 L1_vb2
    s_cmp_lt_i32 s87, 44
    s_cbranch_scc1 L1_vb1
L1_vb0:
    s_waitcnt lgkmcnt(0)
    ds_read_b128 v[216:219], v209 offset:512
    ds_read_b32 v222, v210 offset:46112
    s_add_u32 s80, s80, s80
    s_cbranch_scc0 L1_vs0v0
    v_pk_mul_f32 v[48:49], v[48:49], v[220:221] op_sel_hi:[1,0]
    v_pk_mul_f32 v[50:51], v[50:51], v[220:221] op_sel_hi:[1,0]
    v_pk_mul_f32 v[52:53], v[52:53], v[220:221] op_sel_hi:[1,0]
    v_pk_mul_f32 v[54:55], v[54:55], v[220:221] op_sel_hi:[1,0]
    v_pk_mul_f32 v[56:57], v[56:57], v[220:221] op_sel_hi:[1,0]
    v_pk_mul_f32 v[58:59], v[58:59], v[220:221] op_sel_hi:[1,0]
    v_pk_mul_f32 v[60:61], v[60:61], v[220:221] op_sel_hi:[1,0]
    v_pk_mul_f32 v[62:63], v[62:63], v[220:221] op_sel_hi:[1,0]
    v_pk_mul_f32 v[64:65], v[64:65], v[220:221] op_sel_hi:[1,0]
    v_pk_mul_f32 v[66:67], v[66:67], v[220:221] op_sel_hi:[1,0]
    v_pk_mul_f32 v[68:69], v[68:69], v[220:221] op_sel_hi:[1,0]
    v_pk_mul_f32 v[70:71], v[70:71], v[220:221] op_sel_hi:[1,0]
    v_pk_mul_f32 v[72:73], v[72:73], v[220:221] op_sel_hi:[1,0]
    v_pk_mul_f32 v[74:75], v[74:75], v[220:221] op_sel_hi:[1,0]
    v_pk_mul_f32 v[76:77], v[76:77], v[220:221] op_sel_hi:[1,0]
    v_pk_mul_f32 v[78:79], v[78:79], v[220:221] op_sel_hi:[1,0]
L1_vs0v0:
    s_waitcnt vmcnt(16)
    s_waitcnt vmcnt(12)
    buffer_load_dwordx4 v[176:179], v2, s[24:27], 0 offen offset:0 nt
    v_perm_b32 v32, v84, v80, s44
    v_perm_b32 v33, v92, v88, s44
    v_perm_b32 v34, v100, v96, s44
    v_perm_b32 v35, v108, v104, s44
    v_perm_b32 v36, v84, v80, s45
    v_perm_b32 v37, v92, v88, s45
    v_perm_b32 v38, v100, v96, s45
    v_perm_b32 v39, v108, v104, s45
    v_mfma_f32_16x16x32_bf16 v[48:51], v[32:35], v[212:215], v[48:51]
    s_waitcnt vmcnt(12)
    buffer_load_dwordx4 v[180:183], v2, s[24:27], 0 offen offset:1024 nt
    v_perm_b32 v32, v85, v81, s44
    v_perm_b32 v33, v93, v89, s44
    v_perm_b32 v34, v101, v97, s44
    v_perm_b32 v35, v109, v105, s44
    v_mfma_f32_16x16x32_bf16 v[52:55], v[36:39], v[212:215], v[52:55]
    s_waitcnt vmcnt(12)
    buffer_load_dwordx4 v[184:187], v2, s[24:27], 0 offen offset:2048 nt
    v_perm_b32 v36, v85, v81, s45
    v_perm_b32 v37, v93, v89, s45
    v_perm_b32 v38, v101, v97, s45
    v_perm_b32 v39, v109, v105, s45
    v_mfma_f32_16x16x32_bf16 v[56:59], v[32:35], v[212:215], v[56:59]
    s_waitcnt vmcnt(12)
    buffer_load_dwordx4 v[188:191], v2, s[24:27], 0 offen offset:3072 nt
    v_perm_b32 v32, v86, v82, s44
    v_perm_b32 v33, v94, v90, s44
    v_perm_b32 v34, v102, v98, s44
    v_perm_b32 v35, v110, v106, s44
    v_mfma_f32_16x16x32_bf16 v[60:63], v[36:39], v[212:215], v[60:63]
    s_waitcnt vmcnt(12)
    buffer_load_dwordx4 v[192:195], v2, s[24:27], s52 offen offset:0 nt
    v_perm_b32 v36, v86, v82, s45
    v_perm_b32 v37, v94, v90, s45
    v_perm_b32 v38, v102, v98, s45
    v_perm_b32 v39, v110, v106, s45
    v_mfma_f32_16x16x32_bf16 v[64:67], v[32:35], v[212:215], v[64:67]
    s_waitcnt vmcnt(12)
    buffer_load_dwordx4 v[196:199], v2, s[24:27], s52 offen offset:1024 nt
    v_perm_b32 v32, v87, v83, s44
    v_perm_b32 v33, v95, v91, s44
    v_perm_b32 v34, v103, v99, s44
    v_perm_b32 v35, v111, v107, s44
    v_mfma_f32_16x16x32_bf16 v[68:71], v[36:39], v[212:215], v[68:71]
    s_waitcnt vmcnt(12)
    buffer_load_dwordx4 v[200:203], v2, s[24:27], s52 offen offset:2048 nt
    v_perm_b32 v36, v87, v83, s45
    v_perm_b32 v37, v95, v91, s45
    v_perm_b32 v38, v103, v99, s45
    v_perm_b32 v39, v111, v107, s45
    v_mfma_f32_16x16x32_bf16 v[72:75], v[32:35], v[212:215], v[72:75]
    s_waitcnt vmcnt(12)
    buffer_load_dwordx4 v[204:207], v2, s[24:27], s52 offen offset:3072 nt
    v_add_u32 v2, 0x4000, v2
    v_mfma_f32_16x16x32_bf16 v[76:79], v[36:39], v[212:215], v[76:79]
    s_cmp_eq_u32 s50, 9
    s_cselect_b32 s53, 0x780000, 0
    v_add_u32 v2, s53, v2
    s_waitcnt lgkmcnt(0)
    ds_read_b128 v[212:215], v209 offset:1024
    ds_read_b32 v220, v210 offset:46144
    s_add_u32 s80, s80, s80
    s_cbranch_scc0 L1_vs1v0
    v_pk_mul_f32 v[48:49], v[48:49], v[222:223] op_sel_hi:[1,0]
    v_pk_mul_f32 v[50:51], v[50:51], v[222:223] op_sel_hi:[1,0]
    v_pk_mul_f32 v[52:53], v[52:53], v[222:223] op_sel_hi:[1,0]
    v_pk_mul_f32 v[54:55], v[54:55], v[222:223] op_sel_hi:[1,0]
    v_pk_mul_f32 v[56:57], v[56:57], v[222:223] op_sel_hi:[1,0]
    v_pk_mul_f32 v[58:59], v[58:59], v[222:223] op_sel_hi:[1,0]
    v_pk_mul_f32 v[60:61], v[60:61], v[222:223] op_sel_hi:[1,0]
    v_pk_mul_f32 v[62:63], v[62:63], v[222:223] op_sel_hi:[1,0]
    v_pk_mul_f32 v[64:65], v[64:65], v[222:223] op_sel_hi:[1,0]
    v_pk_mul_f32 v[66:67], v[66:67], v[222:223] op_sel_hi:[1,0]
    v_pk_mul_f32 v[68:69], v[68:69], v[222:223] op_sel_hi:[1,0]
    v_pk_mul_f32 v[70:71], v[70:71], v[222:223] op_sel_hi:[1,0]
    v_pk_mul_f32 v[72:73], v[72:73], v[222:223] op_sel_hi:[1,0]
    v_pk_mul_f32 v[74:75], v[74:75], v[222:223] op_sel_hi:[1,0]
    v_pk_mul_f32 v[76:77], v[76:77], v[222:223] op_sel_hi:[1,0]
    v_pk_mul_f32 v[78:79], v[78:79], v[222:223] op_sel_hi:[1,0]
L1_vs1v0:
    s_waitcnt vmcnt(16)
    s_waitcnt vmcnt(12)
    buffer_load_dwordx4 v[80:83], v2, s[24:27], 0 offen offset:0 nt
    v_perm_b32 v32, v116, v112, s44
    v_perm_b32 v33, v124, v120, s44
    v_perm_b32 v34, v132, v128, s44
    v_perm_b32 v35, v140, v136, s44
    v_perm_b32 v36, v116, v112, s45
    v_perm_b32 v37, v124, v120, s45
    v_perm_b32 v38, v132, v128, s45
    v_perm_b32 v39, v140, v136, s45
    v_mfma_f32_16x16x32_bf16 v[48:51], v[32:35], v[216:219], v[48:51]
    s_waitcnt vmcnt(12)
    buffer_load_dwordx4 v[84:87], v2, s[24:27], 0 offen offset:1024 nt
    v_perm_b32 v32, v117, v113, s44
    v_perm_b32 v33, v125, v121, s44
    v_perm_b32 v34, v133, v129, s44
    v_perm_b32 v35, v141, v137, s44
    v_mfma_f32_16x16x32_bf16 v[52:55], v[36:39], v[216:219], v[52:55]
    s_waitcnt vmcnt(12)
    buffer_load_dwordx4 v[88:91], v2, s[24:27], 0 offen offset:2048 nt
    v_perm_b32 v36, v117, v113, s45
    v_perm_b32 v37, v125, v121, s45
    v_perm_b32 v38, v133, v129, s45
    v_perm_b32 v39, v141, v137, s45
    v_mfma_f32_16x16x32_bf16 v[56:59], v[32:35], v[216:219], v[56:59]
    s_waitcnt vmcnt(12)
    buffer_load_dwordx4 v[92:95], v2, s[24:27], 0 offen offset:3072 nt
    v_perm_b32 v32, v118, v114, s44
    v_perm_b32 v33, v126, v122, s44
    v_perm_b32 v34, v134, v130, s44
    v_perm_b32 v35, v142, v138, s44
    v_mfma_f32_16x16x32_bf16 v[60:63], v[36:39], v[216:219], v[60:63]
    s_waitcnt vmcnt(12)
    buffer_load_dwordx4 v[96:99], v2, s[24:27], s52 offen offset:0 nt
    v_perm_b32 v36, v118, v114, s45
    v_perm_b32 v37, v126, v122, s45
    v_perm_b32 v38, v134, v130, s45
    v_perm_b32 v39, v142, v138, s45
    v_mfma_f32_16x16x32_bf16 v[64:67], v[32:35], v[216:219], v[64:67]
    s_waitcnt vmcnt(12)
    buffer_load_dwordx4 v[100:103], v2, s[24:27], s52 offen offset:1024 nt
    v_perm_b32 v32, v119, v115, s44
    v_perm_b32 v33, v127, v123, s44
    v_perm_b32 v34, v135, v131, s44
    v_perm_b32 v35, v143, v139, s44
    v_mfma_f32_16x16x32_bf16 v[68:71], v[36:39], v[216:219], v[68:71]
    s_waitcnt vmcnt(12)
    buffer_load_dwordx4 v[104:107], v2, s[24:27], s52 offen offset:2048 nt
    v_perm_b32 v36, v119, v115, s45
    v_perm_b32 v37, v127, v123, s45
    v_perm_b32 v38, v135, v131, s45
    v_perm_b32 v39, v143, v139, s45
    v_mfma_f32_16x16x32_bf16 v[72:75], v[32:35], v[216:219], v[72:75]
    s_waitcnt vmcnt(12)
    buffer_load_dwordx4 v[108:111], v2, s[24:27], s52 offen offset:3072 nt
    v_add_u32 v2, 0x4000, v2
    v_mfma_f32_16x16x32_bf16 v[76:79], v[36:39], v[216:219], v[76:79]
    v_add_u32 v254, 1, v254
    s_mov_b64 exec, s[94:95]
    global_store_dword v253, v254, s[88:89]
    s_mov_b64 exec, -1
    global_load_dword v252, v253, s[88:89]
    s_cmp_le_u32 s50, 6
    s_cbranch_scc1 L1_vmix
    s_waitcnt lgkmcnt(0)
    ds_read_b128 v[216:219], v209 offset:1536
    ds_read_b32 v222, v210 offset:46176
    s_add_u32 s80, s80, s80
    s_cbranch_scc0 L1_vs2v0
    v_pk_mul_f32 v[48:49], v[48:49], v[220:221] op_sel_hi:[1,0]
    v_pk_mul_f32 v[50:51], v[50:51], v[220:221] op_sel_hi:[1,0]
    v_pk_mul_f32 v[52:53], v[52:53], v[220:221] op_sel_hi:[1,0]
    v_pk_mul_f32 v[54:55], v[54:55], v[220:221] op_sel_hi:[1,0]
    v_pk_mul_f32 v[56:57], v[56:57], v[220:221] op_sel_hi:[1,0]
    v_pk_mul_f32 v[58:59], v[58:59], v[220:221] op_sel_hi:[1,0]
    v_pk_mul_f32 v[60:61], v[60:61], v[220:221] op_sel_hi:[1,0]
    v_pk_mul_f32 v[62:63], v[62:63], v[220:221] op_sel_hi:[1,0]
    v_pk_mul_f32 v[64:65], v[64:65], v[220:221] op_sel_hi:[1,0]
    v_pk_mul_f32 v[66:67], v[66:67], v[220:221] op_sel_hi:[1,0]
    v_pk_mul_f32 v[68:69], v[68:69], v[220:221] op_sel_hi:[1,0]
    v_pk_mul_f32 v[70:71], v[70:71], v[220:221] op_sel_hi:[1,0]
    v_pk_mul_f32 v[72:73], v[72:73], v[220:221] op_sel_hi:[1,0]
    v_pk_mul_f32 v[74:75], v[74:75], v[220:221] op_sel_hi:[1,0]
    v_pk_mul_f32 v[76:77], v[76:77], v[220:221] op_sel_hi:[1,0]
    v_pk_mul_f32 v[78:79], v[78:79], v[220:221] op_sel_hi:[1,0]
L1_vs2v0:
    s_waitcnt vmcnt(16)
    s_waitcnt vmcnt(13)
    buffer_load_dwordx4 v[112:115], v2, s[24:27], 0 offen offset:0 nt
    v_perm_b32 v32, v148, v144, s44
    v_perm_b32 v33, v156, v152, s44
    v_perm_b32 v34, v164, v160, s44
    v_perm_b32 v35, v172, v168, s44
    v_perm_b32 v36, v148, v144, s45
    v_perm_b32 v37, v156, v152, s45
    v_perm_b32 v38, v164, v160, s45
    v_perm_b32 v39, v172, v168, s45
    v_mfma_f32_16x16x32_bf16 v[48:51], v[32:35], v[212:215], v[48:51]
    s_waitcnt vmcnt(13)
    buffer_load_dwordx4 v[116:119], v2, s[24:27], 0 offen offset:1024 nt
    v_perm_b32 v32, v149, v145, s44
    v_perm_b32 v33, v157, v153, s44
    v_perm_b32 v34, v165, v161, s44
    v_perm_b32 v35, v173, v169, s44
    v_mfma_f32_16x16x32_bf16 v[52:55], v[36:39], v[212:215], v[52:55]
    s_waitcnt vmcnt(13)
    buffer_load_dwordx4 v[120:123], v2, s[24:27], 0 offen offset:2048 nt
    v_perm_b32 v36, v149, v145, s45
    v_perm_b32 v37, v157, v153, s45
    v_perm_b32 v38, v165, v161, s45
    v_perm_b32 v39, v173, v169, s45
    v_mfma_f32_16x16x32_bf16 v[56:59], v[32:35], v[212:215], v[56:59]
    s_waitcnt vmcnt(13)
    buffer_load_dwordx4 v[124:127], v2, s[24:27], 0 offen offset:3072 nt
    v_perm_b32 v32, v150, v146, s44
    v_perm_b32 v33, v158, v154, s44
    v_perm_b32 v34, v166, v162, s44
    v_perm_b32 v35, v174, v170, s44
    v_mfma_f32_16x16x32_bf16 v[60:63], v[36:39], v[212:215], v[60:63]
    s_waitcnt vmcnt(13)
    buffer_load_dwordx4 v[128:131], v2, s[24:27], s52 offen offset:0 nt
    v_perm_b32 v36, v150, v146, s45
    v_perm_b32 v37, v158, v154, s45
    v_perm_b32 v38, v166, v162, s45
    v_perm_b32 v39, v174, v170, s45
    v_mfma_f32_16x16x32_bf16 v[64:67], v[32:35], v[212:215], v[64:67]
    s_waitcnt vmcnt(13)
    buffer_load_dwordx4 v[132:135], v2, s[24:27], s52 offen offset:1024 nt
    v_perm_b32 v32, v151, v147, s44
    v_perm_b32 v33, v159, v155, s44
    v_perm_b32 v34, v167, v163, s44
    v_perm_b32 v35, v175, v171, s44
    v_mfma_f32_16x16x32_bf16 v[68:71], v[36:39], v[212:215], v[68:71]
    s_waitcnt vmcnt(13)
    buffer_load_dwordx4 v[136:139], v2, s[24:27], s52 offen offset:2048 nt
    v_perm_b32 v36, v151, v147, s45
    v_perm_b32 v37, v159, v155, s45
    v_perm_b32 v38, v167, v163, s45
    v_perm_b32 v39, v175, v171, s45
    v_mfma_f32_16x16x32_bf16 v[72:75], v[32:35], v[212:215], v[72:75]
    s_waitcnt vmcnt(13)
    buffer_load_dwordx4 v[140:143], v2, s[24:27], s52 offen offset:3072 nt
    v_add_u32 v2, 0x4000, v2
    v_mfma_f32_16x16x32_bf16 v[76:79], v[36:39], v[212:215], v[76:79]
    s_waitcnt lgkmcnt(0)
    ds_read_b128 v[212:215], v209 offset:2048
    ds_read_b32 v220, v210 offset:46208
    s_add_u32 s80, s80, s80
    s_cbranch_scc0 L1_vs3v0
    v_pk_mul_f32 v[48:49], v[48:49], v[222:223] op_sel_hi:[1,0]
    v_pk_mul_f32 v[50:51], v[50:51], v[222:223] op_sel_hi:[1,0]
    v_pk_mul_f32 v[52:53], v[52:53], v[222:223] op_sel_hi:[1,0]
    v_pk_mul_f32 v[54:55], v[54:55], v[222:223] op_sel_hi:[1,0]
    v_pk_mul_f32 v[56:57], v[56:57], v[222:223] op_sel_hi:[1,0]
    v_pk_mul_f32 v[58:59], v[58:59], v[222:223] op_sel_hi:[1,0]
    v_pk_mul_f32 v[60:61], v[60:61], v[222:223] op_sel_hi:[1,0]
    v_pk_mul_f32 v[62:63], v[62:63], v[222:223] op_sel_hi:[1,0]
    v_pk_mul_f32 v[64:65], v[64:65], v[222:223] op_sel_hi:[1,0]
    v_pk_mul_f32 v[66:67], v[66:67], v[222:223] op_sel_hi:[1,0]
    v_pk_mul_f32 v[68:69], v[68:69], v[222:223] op_sel_hi:[1,0]
    v_pk_mul_f32 v[70:71], v[70:71], v[222:223] op_sel_hi:[1,0]
    v_pk_mul_f32 v[72:73], v[72:73], v[222:223] op_sel_hi:[1,0]
    v_pk_mul_f32 v[74:75], v[74:75], v[222:223] op_sel_hi:[1,0]
    v_pk_mul_f32 v[76:77], v[76:77], v[222:223] op_sel_hi:[1,0]
    v_pk_mul_f32 v[78:79], v[78:79], v[222:223] op_sel_hi:[1,0]
L1_vs3v0:
    s_waitcnt vmcnt(16)
    s_waitcnt vmcnt(12)
    buffer_load_dwordx4 v[144:147], v2, s[24:27], 0 offen offset:0 nt
    v_perm_b32 v32, v180, v176, s44
    v_perm_b32 v33, v188, v184, s44
    v_perm_b32 v34, v196, v192, s44
    v_perm_b32 v35, v204, v200, s44
    v_perm_b32 v36, v180, v176, s45
    v_perm_b32 v37, v188, v184, s45
    v_perm_b32 v38, v196, v192, s45
    v_perm_b32 v39, v204, v200, s45
    v_mfma_f32_16x16x32_bf16 v[48:51], v[32:35], v[216:219], v[48:51]
    s_waitcnt vmcnt(12)
    buffer_load_dwordx4 v[148:151], v2, s[24:27], 0 offen offset:1024 nt
    v_perm_b32 v32, v181, v177, s44
    v_perm_b32 v33, v189, v185, s44
    v_perm_b32 v34, v197, v193, s44
    v_perm_b32 v35, v205, v201, s44
    v_mfma_f32_16x16x32_bf16 v[52:55], v[36:39], v[216:219], v[52:55]
    s_waitcnt vmcnt(12)
    buffer_load_dwordx4 v[152:155], v2, s[24:27], 0 offen offset:2048 nt
    v_perm_b32 v36, v181, v177, s45
    v_perm_b32 v37, v189, v185, s45
    v_perm_b32 v38, v197, v193, s45
    v_perm_b32 v39, v205, v201, s45
    v_mfma_f32_16x16x32_bf16 v[56:59], v[32:35], v[216:219], v[56:59]
    s_waitcnt vmcnt(12)
    buffer_load_dwordx4 v[156:159], v2, s[24:27], 0 offen offset:3072 nt
    v_perm_b32 v32, v182, v178, s44
    v_perm_b32 v33, v190, v186, s44
    v_perm_b32 v34, v198, v194, s44
    v_perm_b32 v35, v206, v202, s44
    v_mfma_f32_16x16x32_bf16 v[60:63], v[36:39], v[216:219], v[60:63]
    s_waitcnt vmcnt(12)
    buffer_load_dwordx4 v[160:163], v2, s[24:27], s52 offen offset:0 nt
    v_perm_b32 v36, v182, v178, s45
    v_perm_b32 v37, v190, v186, s45
    v_perm_b32 v38, v198, v194, s45
    v_perm_b32 v39, v206, v202, s45
    v_mfma_f32_16x16x32_bf16 v[64:67], v[32:35], v[216:219], v[64:67]
    s_waitcnt vmcnt(12)
    buffer_load_dwordx4 v[164:167], v2, s[24:27], s52 offen offset:1024 nt
    v_perm_b32 v32, v183, v179, s44
    v_perm_b32 v33, v191, v187, s44
    v_perm_b32 v34, v199, v195, s44
    v_perm_b32 v35, v207, v203, s44
    v_mfma_f32_16x16x32_bf16 v[68:71], v[36:39], v[216:219], v[68:71]
    s_waitcnt vmcnt(12)
    buffer_load_dwordx4 v[168:171], v2, s[24:27], s52 offen offset:2048 nt
    v_perm_b32 v36, v183, v179, s45
    v_perm_b32 v37, v191, v187, s45
    v_perm_b32 v38, v199, v195, s45
    v_perm_b32 v39, v207, v203, s45
    v_mfma_f32_16x16x32_bf16 v[72:75], v[32:35], v[216:219], v[72:75]
    s_waitcnt vmcnt(12)
    buffer_load_dwordx4 v[172:175], v2, s[24:27], s52 offen offset:3072 nt
    v_add_u32 v2, 0x4000, v2
    v_mfma_f32_16x16x32_bf16 v[76:79], v[36:39], v[216:219], v[76:79]
    s_branch L1_vj
L1_vb1:
    s_waitcnt lgkmcnt(0)
    ds_read_b128 v[216:219], v209 offset:512
    ds_read_b32 v222, v210 offset:46112
    s_add_u32 s80, s80, s80
    s_cbranch_scc0 L1_vs0v1
    v_pk_mul_f32 v[48:49], v[48:49], v[220:221] op_sel_hi:[1,0]
    v_pk_mul_f32 v[50:51], v[50:51], v[220:221] op_sel_hi:[1,0]
    v_pk_mul_f32 v[52:53], v[52:53], v[220:221] op_sel_hi:[1,0]
    v_pk_mul_f32 v[54:55], v[54:55], v[220:221] op_sel_hi:[1,0]
    v_pk_mul_f32 v[56:57], v[56:57], v[220:221] op_sel_hi:[1,0]
    v_pk_mul_f32 v[58:59], v[58:59], v[220:221] op_sel_hi:[1,0]
    v_pk_mul_f32 v[60:61], v[60:61], v[220:221] op_sel_hi:[1,0]
    v_pk_mul_f32 v[62:63], v[62:63], v[220:221] op_sel_hi:[1,0]
    v_pk_mul_f32 v[64:65], v[64:65], v[220:221] op_sel_hi:[1,0]
    v_pk_mul_f32 v[66:67], v[66:67], v[220:221] op_sel_hi:[1,0]
    v_pk_mul_f32 v[68:69], v[68:69], v[220:221] op_sel_hi:[1,0]
    v_pk_mul_f32 v[70:71], v[70:71], v[220:221] op_sel_hi:[1,0]
    v_pk_mul_f32 v[72:73], v[72:73], v[220:221] op_sel_hi:[1,0]
    v_pk_mul_f32 v[74:75], v[74:75], v[220:221] op_sel_hi:[1,0]
    v_pk_mul_f32 v[76:77], v[76:77], v[220:221] op_sel_hi:[1,0]
    v_pk_mul_f32 v[78:79], v[78:79], v[220:221] op_sel_hi:[1,0]
L1_vs0v1:
    s_waitcnt vmcnt(16)
    s_waitcnt vmcnt(10)
    buffer_load_dwordx4 v[176:179], v2, s[24:27], 0 offen offset:0 nt
    v_perm_b32 v32, v84, v80, s44
    v_perm_b32 v33, v92, v88, s44
    v_perm_b32 v34, v100, v96, s44
    v_perm_b32 v35, v108, v104, s44
    v_perm_b32 v36, v84, v80, s45
    v_perm_b32 v37, v92, v88, s45
    v_perm_b32 v38, v100, v96, s45
    v_perm_b32 v39, v108, v104, s45
    v_mfma_f32_16x16x32_bf16 v[48:51], v[32:35], v[212:215], v[48:51]
    s_waitcnt vmcnt(10)
    buffer_load_dwordx4 v[180:183], v2, s[24:27], 0 offen offset:1024 nt
    v_perm_b32 v32, v85, v81, s44
    v_perm_b32 v33, v93, v89, s44
    v_perm_b32 v34, v101, v97, s44
    v_perm_b32 v35, v109, v105, s44
    v_mfma_f32_16x16x32_bf16 v[52:55], v[36:39], v[212:215], v[52:55]
    s_waitcnt vmcnt(10)
    buffer_load_dwordx4 v[184:187], v2, s[24:27], 0 offen offset:2048 nt
    v_perm_b32 v36, v85, v81, s45
    v_perm_b32 v37, v93, v89, s45
    v_perm_b32 v38, v101, v97, s45
    v_perm_b32 v39, v109, v105, s45
    v_mfma_f32_16x16x32_bf16 v[56:59], v[32:35], v[212:215], v[56:59]
    s_waitcnt vmcnt(10)
    buffer_load_dwordx4 v[188:191], v2, s[24:27], 0 offen offset:3072 nt
    v_perm_b32 v32, v86, v82, s44
    v_perm_b32 v33, v94, v90, s44
    v_perm_b32 v34, v102, v98, s44
    v_perm_b32 v35, v110, v106, s44
    v_mfma_f32_16x16x32_bf16 v[60:63], v[36:39], v[212:215], v[60:63]
    s_waitcnt vmcnt(10)
    buffer_load_dwordx4 v[192:195], v2, s[24:27], s52 offen offset:0 nt
    v_perm_b32 v36, v86, v82, s45
    v_perm_b32 v37, v94, v90, s45
    v_perm_b32 v38, v102, v98, s45
    v_perm_b32 v39, v110, v106, s45
    v_mfma_f32_16x16x32_bf16 v[64:67], v[32:35], v[212:215], v[64:67]
    s_waitcnt vmcnt(10)
    buffer_load_dwordx4 v[196:199], v2, s[24:27], s52 offen offset:1024 nt
    v_perm_b32 v32, v87, v83, s44
    v_perm_b32 v33, v95, v91, s44
    v_perm_b32 v34, v103, v99, s44
    v_perm_b32 v35, v111, v107, s44
    v_mfma_f32_16x16x32_bf16 v[68:71], v[36:39], v[212:215], v[68:71]
    s_waitcnt vmcnt(10)
    buffer_load_dwordx4 v[200:203], v2, s[24:27], s52 offen offset:2048 nt
    v_perm_b32 v36, v87, v83, s45
    v_perm_b32 v37, v95, v91, s45
    v_perm_b32 v38, v103, v99, s45
    v_perm_b32 v39, v111, v107, s45
    v_mfma_f32_16x16x32_bf16 v[72:75], v[32:35], v[212:215], v[72:75]
    s_waitcnt vmcnt(10)
    buffer_load_dwordx4 v[204:207], v2, s[24:27], s52 offen offset:3072 nt
    v_add_u32 v2, 0x4000, v2
    v_mfma_f32_16x16x32_bf16 v[76:79], v[36:39], v[212:215], v[76:79]
    s_cmp_eq_u32 s50, 9
    s_cselect_b32 s53, 0x780000, 0
    v_add_u32 v2, s53, v2
    s_waitcnt lgkmcnt(0)
    ds_read_b128 v[212:215], v209 offset:1024
    ds_read_b32 v220, v210 offset:46144
    s_add_u32 s80, s80, s80
    s_cbranch_scc0 L1_vs1v1
    v_pk_mul_f32 v[48:49], v[48:49], v[222:223] op_sel_hi:[1,0]
    v_pk_mul_f32 v[50:51], v[50:51], v[222:223] op_sel_hi:[1,0]
    v_pk_mul_f32 v[52:53], v[52:53], v[222:223] op_sel_hi:[1,0]
    v_pk_mul_f32 v[54:55], v[54:55], v[222:223] op_sel_hi:[1,0]
    v_pk_mul_f32 v[56:57], v[56:57], v[222:223] op_sel_hi:[1,0]
    v_pk_mul_f32 v[58:59], v[58:59], v[222:223] op_sel_hi:[1,0]
    v_pk_mul_f32 v[60:61], v[60:61], v[222:223] op_sel_hi:[1,0]
    v_pk_mul_f32 v[62:63], v[62:63], v[222:223] op_sel_hi:[1,0]
    v_pk_mul_f32 v[64:65], v[64:65], v[222:223] op_sel_hi:[1,0]
    v_pk_mul_f32 v[66:67], v[66:67], v[222:223] op_sel_hi:[1,0]
    v_pk_mul_f32 v[68:69], v[68:69], v[222:223] op_sel_hi:[1,0]
    v_pk_mul_f32 v[70:71], v[70:71], v[222:223] op_sel_hi:[1,0]
    v_pk_mul_f32 v[72:73], v[72:73], v[222:223] op_sel_hi:[1,0]
    v_pk_mul_f32 v[74:75], v[74:75], v[222:223] op_sel_hi:[1,0]
    v_pk_mul_f32 v[76:77], v[76:77], v[222:223] op_sel_hi:[1,0]
    v_pk_mul_f32 v[78:79], v[78:79], v[222:223] op_sel_hi:[1,0]
L1_vs1v1:
    s_waitcnt vmcnt(16)
    s_waitcnt vmcnt(10)
    buffer_load_dwordx4 v[80:83], v2, s[24:27], 0 offen offset:0 nt
    v_perm_b32 v32, v116, v112, s44
    v_perm_b32 v33, v124, v120, s44
    v_perm_b32 v34, v132, v128, s44
    v_perm_b32 v35, v140, v136, s44
    v_perm_b32 v36, v116, v112, s45
    v_perm_b32 v37, v124, v120, s45
    v_perm_b32 v38, v132, v128, s45
    v_perm_b32 v39, v140, v136, s45
    v_mfma_f32_16x16x32_bf16 v[48:51], v[32:35], v[216:219], v[48:51]
    s_waitcnt vmcnt(10)
    buffer_load_dwordx4 v[84:87], v2, s[24:27], 0 offen offset:1024 nt
    v_perm_b32 v32, v117, v113, s44
    v_perm_b32 v33, v125, v121, s44
    v_perm_b32 v34, v133, v129, s44
    v_perm_b32 v35, v141, v137, s44
    v_mfma_f32_16x16x32_bf16 v[52:55], v[36:39], v[216:219], v[52:55]
    s_waitcnt vmcnt(10)
    buffer_load_dwordx4 v[88:91], v2, s[24:27], 0 offen offset:2048 nt
    v_perm_b32 v36, v117, v113, s45
    v_perm_b32 v37, v125, v121, s45
    v_perm_b32 v38, v133, v129, s45
    v_perm_b32 v39, v141, v137, s45
    v_mfma_f32_16x16x32_bf16 v[56:59], v[32:35], v[216:219], v[56:59]
    s_waitcnt vmcnt(10)
    buffer_load_dwordx4 v[92:95], v2, s[24:27], 0 offen offset:3072 nt
    v_perm_b32 v32, v118, v114, s44
    v_perm_b32 v33, v126, v122, s44
    v_perm_b32 v34, v134, v130, s44
    v_perm_b32 v35, v142, v138, s44
    v_mfma_f32_16x16x32_bf16 v[60:63], v[36:39], v[216:219], v[60:63]
    s_waitcnt vmcnt(10)
    buffer_load_dwordx4 v[96:99], v2, s[24:27], s52 offen offset:0 nt
    v_perm_b32 v36, v118, v114, s45
    v_perm_b32 v37, v126, v122, s45
    v_perm_b32 v38, v134, v130, s45
    v_perm_b32 v39, v142, v138, s45
    v_mfma_f32_16x16x32_bf16 v[64:67], v[32:35], v[216:219], v[64:67]
    s_waitcnt vmcnt(10)
    buffer_load_dwordx4 v[100:103], v2, s[24:27], s52 offen offset:1024 nt
    v_perm_b32 v32, v119, v115, s44
    v_perm_b32 v33, v127, v123, s44
    v_perm_b32 v34, v135, v131, s44
    v_perm_b32 v35, v143, v139, s44
    v_mfma_f32_16x16x32_bf16 v[68:71], v[36:39], v[216:219], v[68:71]
    s_waitcnt vmcnt(10)
    buffer_load_dwordx4 v[104:107], v2, s[24:27], s52 offen offset:2048 nt
    v_perm_b32 v36, v119, v115, s45
    v_perm_b32 v37, v127, v123, s45
    v_perm_b32 v38, v135, v131, s45
    v_perm_b32 v39, v143, v139, s45
    v_mfma_f32_16x16x32_bf16 v[72:75], v[32:35], v[216:219], v[72:75]
    s_waitcnt vmcnt(10)
    buffer_load_dwordx4 v[108:111], v2, s[24:27], s52 offen offset:3072 nt
    v_add_u32 v2, 0x4000, v2
    v_mfma_f32_16x16x32_bf16 v[76:79], v[36:39], v[216:219], v[76:79]
    v_add_u32 v254, 1, v254
    s_mov_b64 exec, s[94:95]
    global_store_dword v253, v254, s[88:89]
    s_mov_b64 exec, -1
    global_load_dword v252, v253, s[88:89]
L1_vmix:
    s_waitcnt lgkmcnt(0)
    ds_read_b128 v[216:219], v209 offset:1536
    ds_read_b32 v222, v210 offset:46176
    s_add_u32 s80, s80, s80
    s_cbranch_scc0 L1_vs2v1
    v_pk_mul_f32 v[48:49], v[48:49], v[220:221] op_sel_hi:[1,0]
    v_pk_mul_f32 v[50:51], v[50:51], v[220:221] op_sel_hi:[1,0]
    v_pk_mul_f32 v[52:53], v[52:53], v[220:221] op_sel_hi:[1,0]
    v_pk_mul_f32 v[54:55], v[54:55], v[220:221] op_sel_hi:[1,0]
    v_pk_mul_f32 v[56:57], v[56:57], v[220:221] op_sel_hi:[1,0]
    v_pk_mul_f32 v[58:59], v[58:59], v[220:221] op_sel_hi:[1,0]
    v_pk_mul_f32 v[60:61], v[60:61], v[220:221] op_sel_hi:[1,0]
    v_pk_mul_f32 v[62:63], v[62:63], v[220:221] op_sel_hi:[1,0]
    v_pk_mul_f32 v[64:65], v[64:65], v[220:221] op_sel_hi:[1,0]
    v_pk_mul_f32 v[66:67], v[66:67], v[220:221] op_sel_hi:[1,0]
    v_pk_mul_f32 v[68:69], v[68:69], v[220:221] op_sel_hi:[1,0]
    v_pk_mul_f32 v[70:71], v[70:71], v[220:221] op_sel_hi:[1,0]
    v_pk_mul_f32 v[72:73], v[72:73], v[220:221] op_sel_hi:[1,0]
    v_pk_mul_f32 v[74:75], v[74:75], v[220:221] op_sel_hi:[1,0]
    v_pk_mul_f32 v[76:77], v[76:77], v[220:221] op_sel_hi:[1,0]
    v_pk_mul_f32 v[78:79], v[78:79], v[220:221] op_sel_hi:[1,0]
L1_vs2v1:
    s_waitcnt vmcnt(16)
    s_waitcnt vmcnt(11)
    buffer_load_dwordx4 v[112:115], v2, s[24:27], 0 offen offset:0 nt
    v_perm_b32 v32, v148, v144, s44
    v_perm_b32 v33, v156, v152, s44
    v_perm_b32 v34, v164, v160, s44
    v_perm_b32 v35, v172, v168, s44
    v_perm_b32 v36, v148, v144, s45
    v_perm_b32 v37, v156, v152, s45
    v_perm_b32 v38, v164, v160, s45
    v_perm_b32 v39, v172, v168, s45
    v_mfma_f32_16x16x32_bf16 v[48:51], v[32:35], v[212:215], v[48:51]
    s_waitcnt vmcnt(11)
    buffer_load_dwordx4 v[116:119], v2, s[24:27], 0 offen offset:1024 nt
    v_perm_b32 v32, v149, v145, s44
    v_perm_b32 v33, v157, v153, s44
    v_perm_b32 v34, v165, v161, s44
    v_perm_b32 v35, v173, v169, s44
    v_mfma_f32_16x16x32_bf16 v[52:55], v[36:39], v[212:215], v[52:55]
    s_waitcnt vmcnt(11)
    buffer_load_dwordx4 v[120:123], v2, s[24:27], 0 offen offset:2048 nt
    v_perm_b32 v36, v149, v145, s45
    v_perm_b32 v37, v157, v153, s45
    v_perm_b32 v38, v165, v161, s45
    v_perm_b32 v39, v173, v169, s45
    v_mfma_f32_16x16x32_bf16 v[56:59], v[32:35], v[212:215], v[56:59]
    s_waitcnt vmcnt(11)
    buffer_load_dwordx4 v[124:127], v2, s[24:27], 0 offen offset:3072 nt
    v_perm_b32 v32, v150, v146, s44
    v_perm_b32 v33, v158, v154, s44
    v_perm_b32 v34, v166, v162, s44
    v_perm_b32 v35, v174, v170, s44
    v_mfma_f32_16x16x32_bf16 v[60:63], v[36:39], v[212:215], v[60:63]
    s_waitcnt vmcnt(11)
    buffer_load_dwordx4 v[128:131], v2, s[24:27], s52 offen offset:0 nt
    v_perm_b32 v36, v150, v146, s45
    v_perm_b32 v37, v158, v154, s45
    v_perm_b32 v38, v166, v162, s45
    v_perm_b32 v39, v174, v170, s45
    v_mfma_f32_16x16x32_bf16 v[64:67], v[32:35], v[212:215], v[64:67]
    s_waitcnt vmcnt(11)
    buffer_load_dwordx4 v[132:135], v2, s[24:27], s52 offen offset:1024 nt
    v_perm_b32 v32, v151, v147, s44
    v_perm_b32 v33, v159, v155, s44
    v_perm_b32 v34, v167, v163, s44
    v_perm_b32 v35, v175, v171, s44
    v_mfma_f32_16x16x32_bf16 v[68:71], v[36:39], v[212:215], v[68:71]
    s_waitcnt vmcnt(11)
    buffer_load_dwordx4 v[136:139], v2, s[24:27], s52 offen offset:2048 nt
    v_perm_b32 v36, v151, v147, s45
    v_perm_b32 v37, v159, v155, s45
    v_perm_b32 v38, v167, v163, s45
    v_perm_b32 v39, v175, v171, s45
    v_mfma_f32_16x16x32_bf16 v[72:75], v[32:35], v[212:215], v[72:75]
    s_waitcnt vmcnt(11)
    buffer_load_dwordx4 v[140:143], v2, s[24:27], s52 offen offset:3072 nt
    v_add_u32 v2, 0x4000, v2
    v_mfma_f32_16x16x32_bf16 v[76:79], v[36:39], v[212:215], v[76:79]
    s_waitcnt lgkmcnt(0)
    ds_read_b128 v[212:215], v209 offset:2048
    ds_read_b32 v220, v210 offset:46208
    s_add_u32 s80, s80, s80
    s_cbranch_scc0 L1_vs3v1
    v_pk_mul_f32 v[48:49], v[48:49], v[222:223] op_sel_hi:[1,0]
    v_pk_mul_f32 v[50:51], v[50:51], v[222:223] op_sel_hi:[1,0]
    v_pk_mul_f32 v[52:53], v[52:53], v[222:223] op_sel_hi:[1,0]
    v_pk_mul_f32 v[54:55], v[54:55], v[222:223] op_sel_hi:[1,0]
    v_pk_mul_f32 v[56:57], v[56:57], v[222:223] op_sel_hi:[1,0]
    v_pk_mul_f32 v[58:59], v[58:59], v[222:223] op_sel_hi:[1,0]
    v_pk_mul_f32 v[60:61], v[60:61], v[222:223] op_sel_hi:[1,0]
    v_pk_mul_f32 v[62:63], v[62:63], v[222:223] op_sel_hi:[1,0]
    v_pk_mul_f32 v[64:65], v[64:65], v[222:223] op_sel_hi:[1,0]
    v_pk_mul_f32 v[66:67], v[66:67], v[222:223] op_sel_hi:[1,0]
    v_pk_mul_f32 v[68:69], v[68:69], v[222:223] op_sel_hi:[1,0]
    v_pk_mul_f32 v[70:71], v[70:71], v[222:223] op_sel_hi:[1,0]
    v_pk_mul_f32 v[72:73], v[72:73], v[222:223] op_sel_hi:[1,0]
    v_pk_mul_f32 v[74:75], v[74:75], v[222:223] op_sel_hi:[1,0]
    v_pk_mul_f32 v[76:77], v[76:77], v[222:223] op_sel_hi:[1,0]
    v_pk_mul_f32 v[78:79], v[78:79], v[222:223] op_sel_hi:[1,0]
L1_vs3v1:
    s_waitcnt vmcnt(16)
    s_waitcnt vmcnt(10)
    buffer_load_dwordx4 v[144:147], v2, s[24:27], 0 offen offset:0 nt
    v_perm_b32 v32, v180, v176, s44
    v_perm_b32 v33, v188, v184, s44
    v_perm_b32 v34, v196, v192, s44
    v_perm_b32 v35, v204, v200, s44
    v_perm_b32 v36, v180, v176, s45
    v_perm_b32 v37, v188, v184, s45
    v_perm_b32 v38, v196, v192, s45
    v_perm_b32 v39, v204, v200, s45
    v_mfma_f32_16x16x32_bf16 v[48:51], v[32:35], v[216:219], v[48:51]
    s_waitcnt vmcnt(10)
    buffer_load_dwordx4 v[148:151], v2, s[24:27], 0 offen offset:1024 nt
    v_perm_b32 v32, v181, v177, s44
    v_perm_b32 v33, v189, v185, s44
    v_perm_b32 v34, v197, v193, s44
    v_perm_b32 v35, v205, v201, s44
    v_mfma_f32_16x16x32_bf16 v[52:55], v[36:39], v[216:219], v[52:55]
    s_waitcnt vmcnt(10)
    buffer_load_dwordx4 v[152:155], v2, s[24:27], 0 offen offset:2048 nt
    v_perm_b32 v36, v181, v177, s45
    v_perm_b32 v37, v189, v185, s45
    v_perm_b32 v38, v197, v193, s45
    v_perm_b32 v39, v205, v201, s45
    v_mfma_f32_16x16x32_bf16 v[56:59], v[32:35], v[216:219], v[56:59]
    s_waitcnt vmcnt(10)
    buffer_load_dwordx4 v[156:159], v2, s[24:27], 0 offen offset:3072 nt
    v_perm_b32 v32, v182, v178, s44
    v_perm_b32 v33, v190, v186, s44
    v_perm_b32 v34, v198, v194, s44
    v_perm_b32 v35, v206, v202, s44
    v_mfma_f32_16x16x32_bf16 v[60:63], v[36:39], v[216:219], v[60:63]
    s_waitcnt vmcnt(10)
    buffer_load_dwordx4 v[160:163], v2, s[24:27], s52 offen offset:0 nt
    v_perm_b32 v36, v182, v178, s45
    v_perm_b32 v37, v190, v186, s45
    v_perm_b32 v38, v198, v194, s45
    v_perm_b32 v39, v206, v202, s45
    v_mfma_f32_16x16x32_bf16 v[64:67], v[32:35], v[216:219], v[64:67]
    s_waitcnt vmcnt(10)
    buffer_load_dwordx4 v[164:167], v2, s[24:27], s52 offen offset:1024 nt
    v_perm_b32 v32, v183, v179, s44
    v_perm_b32 v33, v191, v187, s44
    v_perm_b32 v34, v199, v195, s44
    v_perm_b32 v35, v207, v203, s44
    v_mfma_f32_16x16x32_bf16 v[68:71], v[36:39], v[216:219], v[68:71]
    s_waitcnt vmcnt(10)
    buffer_load_dwordx4 v[168:171], v2, s[24:27], s52 offen offset:2048 nt
    v_perm_b32 v36, v183, v179, s45
    v_perm_b32 v37, v191, v187, s45
    v_perm_b32 v38, v199, v195, s45
    v_perm_b32 v39, v207, v203, s45
    v_mfma_f32_16x16x32_bf16 v[72:75], v[32:35], v[216:219], v[72:75]
    s_waitcnt vmcnt(10)
    buffer_load_dwordx4 v[172:175], v2, s[24:27], s52 offen offset:3072 nt
    v_add_u32 v2, 0x4000, v2
    v_mfma_f32_16x16x32_bf16 v[76:79], v[36:39], v[216:219], v[76:79]
    s_branch L1_vj
L1_vb2:
    s_waitcnt lgkmcnt(0)
    ds_read_b128 v[216:219], v209 offset:512
    ds_read_b32 v222, v210 offset:46112
    s_add_u32 s80, s80, s80
    s_cbranch_scc0 L1_vs0v2
    v_pk_mul_f32 v[48:49], v[48:49], v[220:221] op_sel_hi:[1,0]
    v_pk_mul_f32 v[50:51], v[50:51], v[220:221] op_sel_hi:[1,0]
    v_pk_mul_f32 v[52:53], v[52:53], v[220:221] op_sel_hi:[1,0]
    v_pk_mul_f32 v[54:55], v[54:55], v[220:221] op_sel_hi:[1,0]
    v_pk_mul_f32 v[56:57], v[56:57], v[220:221] op_sel_hi:[1,0]
    v_pk_mul_f32 v[58:59], v[58:59], v[220:221] op_sel_hi:[1,0]
    v_pk_mul_f32 v[60:61], v[60:61], v[220:221] op_sel_hi:[1,0]
    v_pk_mul_f32 v[62:63], v[62:63], v[220:221] op_sel_hi:[1,0]
    v_pk_mul_f32 v[64:65], v[64:65], v[220:221] op_sel_hi:[1,0]
    v_pk_mul_f32 v[66:67], v[66:67], v[220:221] op_sel_hi:[1,0]
    v_pk_mul_f32 v[68:69], v[68:69], v[220:221] op_sel_hi:[1,0]
    v_pk_mul_f32 v[70:71], v[70:71], v[220:221] op_sel_hi:[1,0]
    v_pk_mul_f32 v[72:73], v[72:73], v[220:221] op_sel_hi:[1,0]
    v_pk_mul_f32 v[74:75], v[74:75], v[220:221] op_sel_hi:[1,0]
    v_pk_mul_f32 v[76:77], v[76:77], v[220:221] op_sel_hi:[1,0]
    v_pk_mul_f32 v[78:79], v[78:79], v[220:221] op_sel_hi:[1,0]
L1_vs0v2:
    s_waitcnt vmcnt(16)
    s_waitcnt vmcnt(8)
    buffer_load_dwordx4 v[176:179], v2, s[24:27], 0 offen offset:0 nt
    v_perm_b32 v32, v84, v80, s44
    v_perm_b32 v33, v92, v88, s44
    v_perm_b32 v34, v100, v96, s44
    v_perm_b32 v35, v108, v104, s44
    v_perm_b32 v36, v84, v80, s45
    v_perm_b32 v37, v92, v88, s45
    v_perm_b32 v38, v100, v96, s45
    v_perm_b32 v39, v108, v104, s45
    v_mfma_f32_16x16x32_bf16 v[48:51], v[32:35], v[212:215], v[48:51]
    s_waitcnt vmcnt(8)
    buffer_load_dwordx4 v[180:183], v2, s[24:27], 0 offen offset:1024 nt
    v_perm_b32 v32, v85, v81, s44
    v_perm_b32 v33, v93, v89, s44
    v_perm_b32 v34, v101, v97, s44
    v_perm_b32 v35, v109, v105, s44
    v_mfma_f32_16x16x32_bf16 v[52:55], v[36:39], v[212:215], v[52:55]
    s_waitcnt vmcnt(8)
    buffer_load_dwordx4 v[184:187], v2, s[24:27], 0 offen offset:2048 nt
    v_perm_b32 v36, v85, v81, s45
    v_perm_b32 v37, v93, v89, s45
    v_perm_b32 v38, v101, v97, s45
    v_perm_b32 v39, v109, v105, s45
    v_mfma_f32_16x16x32_bf16 v[56:59], v[32:35], v[212:215], v[56:59]
    s_waitcnt vmcnt(8)
    buffer_load_dwordx4 v[188:191], v2, s[24:27], 0 offen offset:3072 nt
    v_perm_b32 v32, v86, v82, s44
    v_perm_b32 v33, v94, v90, s44
    v_perm_b32 v34, v102, v98, s44
    v_perm_b32 v35, v110, v106, s44
    v_mfma_f32_16x16x32_bf16 v[60:63], v[36:39], v[212:215], v[60:63]
    s_waitcnt vmcnt(8)
    buffer_load_dwordx4 v[192:195], v2, s[24:27], s52 offen offset:0 nt
    v_perm_b32 v36, v86, v82, s45
    v_perm_b32 v37, v94, v90, s45
    v_perm_b32 v38, v102, v98, s45
    v_perm_b32 v39, v110, v106, s45
    v_mfma_f32_16x16x32_bf16 v[64:67], v[32:35], v[212:215], v[64:67]
    s_waitcnt vmcnt(8)
    buffer_load_dwordx4 v[196:199], v2, s[24:27], s52 offen offset:1024 nt
    v_perm_b32 v32, v87, v83, s44
    v_perm_b32 v33, v95, v91, s44
    v_perm_b32 v34, v103, v99, s44
    v_perm_b32 v35, v111, v107, s44
    v_mfma_f32_16x16x32_bf16 v[68:71], v[36:39], v[212:215], v[68:71]
    s_waitcnt vmcnt(8)
    buffer_load_dwordx4 v[200:203], v2, s[24:27], s52 offen offset:2048 nt
    v_perm_b32 v36, v87, v83, s45
    v_perm_b32 v37, v95, v91, s45
    v_perm_b32 v38, v103, v99, s45
    v_perm_b32 v39, v111, v107, s45
    v_mfma_f32_16x16x32_bf16 v[72:75], v[32:35], v[212:215], v[72:75]
    s_waitcnt vmcnt(8)
    buffer_load_dwordx4 v[204:207], v2, s[24:27], s52 offen offset:3072 nt
    v_add_u32 v2, 0x4000, v2
    v_mfma_f32_16x16x32_bf16 v[76:79], v[36:39], v[212:215], v[76:79]
    s_cmp_eq_u32 s50, 9
    s_cselect_b32 s53, 0x780000, 0
    v_add_u32 v2, s53, v2
    s_waitcnt lgkmcnt(0)
    ds_read_b128 v[212:215], v209 offset:1024
    ds_read_b32 v220, v210 offset:46144
    s_add_u32 s80, s80, s80
    s_cbranch_scc0 L1_vs1v2
    v_pk_mul_f32 v[48:49], v[48:49], v[222:223] op_sel_hi:[1,0]
    v_pk_mul_f32 v[50:51], v[50:51], v[222:223] op_sel_hi:[1,0]
    v_pk_mul_f32 v[52:53], v[52:53], v[222:223] op_sel_hi:[1,0]
    v_pk_mul_f32 v[54:55], v[54:55], v[222:223] op_sel_hi:[1,0]
    v_pk_mul_f32 v[56:57], v[56:57], v[222:223] op_sel_hi:[1,0]
    v_pk_mul_f32 v[58:59], v[58:59], v[222:223] op_sel_hi:[1,0]
    v_pk_mul_f32 v[60:61], v[60:61], v[222:223] op_sel_hi:[1,0]
    v_pk_mul_f32 v[62:63], v[62:63], v[222:223] op_sel_hi:[1,0]
    v_pk_mul_f32 v[64:65], v[64:65], v[222:223] op_sel_hi:[1,0]
    v_pk_mul_f32 v[66:67], v[66:67], v[222:223] op_sel_hi:[1,0]
    v_pk_mul_f32 v[68:69], v[68:69], v[222:223] op_sel_hi:[1,0]
    v_pk_mul_f32 v[70:71], v[70:71], v[222:223] op_sel_hi:[1,0]
    v_pk_mul_f32 v[72:73], v[72:73], v[222:223] op_sel_hi:[1,0]
    v_pk_mul_f32 v[74:75], v[74:75], v[222:223] op_sel_hi:[1,0]
    v_pk_mul_f32 v[76:77], v[76:77], v[222:223] op_sel_hi:[1,0]
    v_pk_mul_f32 v[78:79], v[78:79], v[222:223] op_sel_hi:[1,0]
L1_vs1v2:
    s_waitcnt vmcnt(16)
    s_waitcnt vmcnt(8)
    buffer_load_dwordx4 v[80:83], v2, s[24:27], 0 offen offset:0 nt
    v_perm_b32 v32, v116, v112, s44
    v_perm_b32 v33, v124, v120, s44
    v_perm_b32 v34, v132, v128, s44
    v_perm_b32 v35, v140, v136, s44
    v_perm_b32 v36, v116, v112, s45
    v_perm_b32 v37, v124, v120, s45
    v_perm_b32 v38, v132, v128, s45
    v_perm_b32 v39, v140, v136, s45
    v_mfma_f32_16x16x32_bf16 v[48:51], v[32:35], v[216:219], v[48:51]
    s_waitcnt vmcnt(8)
    buffer_load_dwordx4 v[84:87], v2, s[24:27], 0 offen offset:1024 nt
    v_perm_b32 v32, v117, v113, s44
    v_perm_b32 v33, v125, v121, s44
    v_perm_b32 v34, v133, v129, s44
    v_perm_b32 v35, v141, v137, s44
    v_mfma_f32_16x16x32_bf16 v[52:55], v[36:39], v[216:219], v[52:55]
    s_waitcnt vmcnt(8)
    buffer_load_dwordx4 v[88:91], v2, s[24:27], 0 offen offset:2048 nt
    v_perm_b32 v36, v117, v113, s45
    v_perm_b32 v37, v125, v121, s45
    v_perm_b32 v38, v133, v129, s45
    v_perm_b32 v39, v141, v137, s45
    v_mfma_f32_16x16x32_bf16 v[56:59], v[32:35], v[216:219], v[56:59]
    s_waitcnt vmcnt(8)
    buffer_load_dwordx4 v[92:95], v2, s[24:27], 0 offen offset:3072 nt
    v_perm_b32 v32, v118, v114, s44
    v_perm_b32 v33, v126, v122, s44
    v_perm_b32 v34, v134, v130, s44
    v_perm_b32 v35, v142, v138, s44
    v_mfma_f32_16x16x32_bf16 v[60:63], v[36:39], v[216:219], v[60:63]
    s_waitcnt vmcnt(8)
    buffer_load_dwordx4 v[96:99], v2, s[24:27], s52 offen offset:0 nt
    v_perm_b32 v36, v118, v114, s45
    v_perm_b32 v37, v126, v122, s45
    v_perm_b32 v38, v134, v130, s45
    v_perm_b32 v39, v142, v138, s45
    v_mfma_f32_16x16x32_bf16 v[64:67], v[32:35], v[216:219], v[64:67]
    s_waitcnt vmcnt(8)
    buffer_load_dwordx4 v[100:103], v2, s[24:27], s52 offen offset:1024 nt
    v_perm_b32 v32, v119, v115, s44
    v_perm_b32 v33, v127, v123, s44
    v_perm_b32 v34, v135, v131, s44
    v_perm_b32 v35, v143, v139, s44
    v_mfma_f32_16x16x32_bf16 v[68:71], v[36:39], v[216:219], v[68:71]
    s_waitcnt vmcnt(8)
    buffer_load_dwordx4 v[104:107], v2, s[24:27], s52 offen offset:2048 nt
    v_perm_b32 v36, v119, v115, s45
    v_perm_b32 v37, v127, v123, s45
    v_perm_b32 v38, v135, v131, s45
    v_perm_b32 v39, v143, v139, s45
    v_mfma_f32_16x16x32_bf16 v[72:75], v[32:35], v[216:219], v[72:75]
    s_waitcnt vmcnt(8)
    buffer_load_dwordx4 v[108:111], v2, s[24:27], s52 offen offset:3072 nt
    v_add_u32 v2, 0x4000, v2
    v_mfma_f32_16x16x32_bf16 v[76:79], v[36:39], v[216:219], v[76:79]
    v_add_u32 v254, 1, v254
    s_mov_b64 exec, s[94:95]
    global_store_dword v253, v254, s[88:89]
    s_mov_b64 exec, -1
    global_load_dword v252, v253, s[88:89]
    s_cmp_le_u32 s50, 6
    s_cbranch_scc1 L1_vmix
    s_waitcnt lgkmcnt(0)
    ds_read_b128 v[216:219], v209 offset:1536
    ds_read_b32 v222, v210 offset:46176
    s_add_u32 s80, s80, s80
    s_cbranch_scc0 L1_vs2v2
    v_pk_mul_f32 v[48:49], v[48:49], v[220:221] op_sel_hi:[1,0]
    v_pk_mul_f32 v[50:51], v[50:51], v[220:221] op_sel_hi:[1,0]
    v_pk_mul_f32 v[52:53], v[52:53], v[220:221] op_sel_hi:[1,0]
    v_pk_mul_f32 v[54:55], v[54:55], v[220:221] op_sel_hi:[1,0]
    v_pk_mul_f32 v[56:57], v[56:57], v[220:221] op_sel_hi:[1,0]
    v_pk_mul_f32 v[58:59], v[58:59], v[220:221] op_sel_hi:[1,0]
    v_pk_mul_f32 v[60:61], v[60:61], v[220:221] op_sel_hi:[1,0]
    v_pk_mul_f32 v[62:63], v[62:63], v[220:221] op_sel_hi:[1,0]
    v_pk_mul_f32 v[64:65], v[64:65], v[220:221] op_sel_hi:[1,0]
    v_pk_mul_f32 v[66:67], v[66:67], v[220:221] op_sel_hi:[1,0]
    v_pk_mul_f32 v[68:69], v[68:69], v[220:221] op_sel_hi:[1,0]
    v_pk_mul_f32 v[70:71], v[70:71], v[220:221] op_sel_hi:[1,0]
    v_pk_mul_f32 v[72:73], v[72:73], v[220:221] op_sel_hi:[1,0]
    v_pk_mul_f32 v[74:75], v[74:75], v[220:221] op_sel_hi:[1,0]
    v_pk_mul_f32 v[76:77], v[76:77], v[220:221] op_sel_hi:[1,0]
    v_pk_mul_f32 v[78:79], v[78:79], v[220:221] op_sel_hi:[1,0]
L1_vs2v2:
    s_waitcnt vmcnt(16)
    s_waitcnt vmcnt(9)
    buffer_load_dwordx4 v[112:115], v2, s[24:27], 0 offen offset:0 nt
    v_perm_b32 v32, v148, v144, s44
    v_perm_b32 v33, v156, v152, s44
    v_perm_b32 v34, v164, v160, s44
    v_perm_b32 v35, v172, v168, s44
    v_perm_b32 v36, v148, v144, s45
    v_perm_b32 v37, v156, v152, s45
    v_perm_b32 v38, v164, v160, s45
    v_perm_b32 v39, v172, v168, s45
    v_mfma_f32_16x16x32_bf16 v[48:51], v[32:35], v[212:215], v[48:51]
    s_waitcnt vmcnt(9)
    buffer_load_dwordx4 v[116:119], v2, s[24:27], 0 offen offset:1024 nt
    v_perm_b32 v32, v149, v145, s44
    v_perm_b32 v33, v157, v153, s44
    v_perm_b32 v34, v165, v161, s44
    v_perm_b32 v35, v173, v169, s44
    v_mfma_f32_16x16x32_bf16 v[52:55], v[36:39], v[212:215], v[52:55]
    s_waitcnt vmcnt(9)
    buffer_load_dwordx4 v[120:123], v2, s[24:27], 0 offen offset:2048 nt
    v_perm_b32 v36, v149, v145, s45
    v_perm_b32 v37, v157, v153, s45
    v_perm_b32 v38, v165, v161, s45
    v_perm_b32 v39, v173, v169, s45
    v_mfma_f32_16x16x32_bf16 v[56:59], v[32:35], v[212:215], v[56:59]
    s_waitcnt vmcnt(9)
    buffer_load_dwordx4 v[124:127], v2, s[24:27], 0 offen offset:3072 nt
    v_perm_b32 v32, v150, v146, s44
    v_perm_b32 v33, v158, v154, s44
    v_perm_b32 v34, v166, v162, s44
    v_perm_b32 v35, v174, v170, s44
    v_mfma_f32_16x16x32_bf16 v[60:63], v[36:39], v[212:215], v[60:63]
    s_waitcnt vmcnt(9)
    buffer_load_dwordx4 v[128:131], v2, s[24:27], s52 offen offset:0 nt
    v_perm_b32 v36, v150, v146, s45
    v_perm_b32 v37, v158, v154, s45
    v_perm_b32 v38, v166, v162, s45
    v_perm_b32 v39, v174, v170, s45
    v_mfma_f32_16x16x32_bf16 v[64:67], v[32:35], v[212:215], v[64:67]
    s_waitcnt vmcnt(9)
    buffer_load_dwordx4 v[132:135], v2, s[24:27], s52 offen offset:1024 nt
    v_perm_b32 v32, v151, v147, s44
    v_perm_b32 v33, v159, v155, s44
    v_perm_b32 v34, v167, v163, s44
    v_perm_b32 v35, v175, v171, s44
    v_mfma_f32_16x16x32_bf16 v[68:71], v[36:39], v[212:215], v[68:71]
    s_waitcnt vmcnt(9)
    buffer_load_dwordx4 v[136:139], v2, s[24:27], s52 offen offset:2048 nt
    v_perm_b32 v36, v151, v147, s45
    v_perm_b32 v37, v159, v155, s45
    v_perm_b32 v38, v167, v163, s45
    v_perm_b32 v39, v175, v171, s45
    v_mfma_f32_16x16x32_bf16 v[72:75], v[32:35], v[212:215], v[72:75]
    s_waitcnt vmcnt(9)
    buffer_load_dwordx4 v[140:143], v2, s[24:27], s52 offen offset:3072 nt
    v_add_u32 v2, 0x4000, v2
    v_mfma_f32_16x16x32_bf16 v[76:79], v[36:39], v[212:215], v[76:79]
    s_waitcnt lgkmcnt(0)
    ds_read_b128 v[212:215], v209 offset:2048
    ds_read_b32 v220, v210 offset:46208
    s_add_u32 s80, s80, s80
    s_cbranch_scc0 L1_vs3v2
    v_pk_mul_f32 v[48:49], v[48:49], v[222:223] op_sel_hi:[1,0]
    v_pk_mul_f32 v[50:51], v[50:51], v[222:223] op_sel_hi:[1,0]
    v_pk_mul_f32 v[52:53], v[52:53], v[222:223] op_sel_hi:[1,0]
    v_pk_mul_f32 v[54:55], v[54:55], v[222:223] op_sel_hi:[1,0]
    v_pk_mul_f32 v[56:57], v[56:57], v[222:223] op_sel_hi:[1,0]
    v_pk_mul_f32 v[58:59], v[58:59], v[222:223] op_sel_hi:[1,0]
    v_pk_mul_f32 v[60:61], v[60:61], v[222:223] op_sel_hi:[1,0]
    v_pk_mul_f32 v[62:63], v[62:63], v[222:223] op_sel_hi:[1,0]
    v_pk_mul_f32 v[64:65], v[64:65], v[222:223] op_sel_hi:[1,0]
    v_pk_mul_f32 v[66:67], v[66:67], v[222:223] op_sel_hi:[1,0]
    v_pk_mul_f32 v[68:69], v[68:69], v[222:223] op_sel_hi:[1,0]
    v_pk_mul_f32 v[70:71], v[70:71], v[222:223] op_sel_hi:[1,0]
    v_pk_mul_f32 v[72:73], v[72:73], v[222:223] op_sel_hi:[1,0]
    v_pk_mul_f32 v[74:75], v[74:75], v[222:223] op_sel_hi:[1,0]
    v_pk_mul_f32 v[76:77], v[76:77], v[222:223] op_sel_hi:[1,0]
    v_pk_mul_f32 v[78:79], v[78:79], v[222:223] op_sel_hi:[1,0]
L1_vs3v2:
    s_waitcnt vmcnt(16)
    s_waitcnt vmcnt(8)
    buffer_load_dwordx4 v[144:147], v2, s[24:27], 0 offen offset:0 nt
    v_perm_b32 v32, v180, v176, s44
    v_perm_b32 v33, v188, v184, s44
    v_perm_b32 v34, v196, v192, s44
    v_perm_b32 v35, v204, v200, s44
    v_perm_b32 v36, v180, v176, s45
    v_perm_b32 v37, v188, v184, s45
    v_perm_b32 v38, v196, v192, s45
    v_perm_b32 v39, v204, v200, s45
    v_mfma_f32_16x16x32_bf16 v[48:51], v[32:35], v[216:219], v[48:51]
    s_waitcnt vmcnt(8)
    buffer_load_dwordx4 v[148:151], v2, s[24:27], 0 offen offset:1024 nt
    v_perm_b32 v32, v181, v177, s44
    v_perm_b32 v33, v189, v185, s44
    v_perm_b32 v34, v197, v193, s44
    v_perm_b32 v35, v205, v201, s44
    v_mfma_f32_16x16x32_bf16 v[52:55], v[36:39], v[216:219], v[52:55]
    s_waitcnt vmcnt(8)
    buffer_load_dwordx4 v[152:155], v2, s[24:27], 0 offen offset:2048 nt
    v_perm_b32 v36, v181, v177, s45
    v_perm_b32 v37, v189, v185, s45
    v_perm_b32 v38, v197, v193, s45
    v_perm_b32 v39, v205, v201, s45
    v_mfma_f32_16x16x32_bf16 v[56:59], v[32:35], v[216:219], v[56:59]
    s_waitcnt vmcnt(8)
    buffer_load_dwordx4 v[156:159], v2, s[24:27], 0 offen offset:3072 nt
    v_perm_b32 v32, v182, v178, s44
    v_perm_b32 v33, v190, v186, s44
    v_perm_b32 v34, v198, v194, s44
    v_perm_b32 v35, v206, v202, s44
    v_mfma_f32_16x16x32_bf16 v[60:63], v[36:39], v[216:219], v[60:63]
    s_waitcnt vmcnt(8)
    buffer_load_dwordx4 v[160:163], v2, s[24:27], s52 offen offset:0 nt
    v_perm_b32 v36, v182, v178, s45
    v_perm_b32 v37, v190, v186, s45
    v_perm_b32 v38, v198, v194, s45
    v_perm_b32 v39, v206, v202, s45
    v_mfma_f32_16x16x32_bf16 v[64:67], v[32:35], v[216:219], v[64:67]
    s_waitcnt vmcnt(8)
    buffer_load_dwordx4 v[164:167], v2, s[24:27], s52 offen offset:1024 nt
    v_perm_b32 v32, v183, v179, s44
    v_perm_b32 v33, v191, v187, s44
    v_perm_b32 v34, v199, v195, s44
    v_perm_b32 v35, v207, v203, s44
    v_mfma_f32_16x16x32_bf16 v[68:71], v[36:39], v[216:219], v[68:71]
    s_waitcnt vmcnt(8)
    buffer_load_dwordx4 v[168:171], v2, s[24:27], s52 offen offset:2048 nt
    v_perm_b32 v36, v183, v179, s45
    v_perm_b32 v37, v191, v187, s45
    v_perm_b32 v38, v199, v195, s45
    v_perm_b32 v39, v207, v203, s45
    v_mfma_f32_16x16x32_bf16 v[72:75], v[32:35], v[216:219], v[72:75]
    s_waitcnt vmcnt(8)
    buffer_load_dwordx4 v[172:175], v2, s[24:27], s52 offen offset:3072 nt
    v_add_u32 v2, 0x4000, v2
    v_mfma_f32_16x16x32_bf16 v[76:79], v[36:39], v[216:219], v[76:79]
    s_branch L1_vj
L1_vb3:
    s_waitcnt lgkmcnt(0)
    ds_read_b128 v[216:219], v209 offset:512
    ds_read_b32 v222, v210 offset:46112
    s_add_u32 s80, s80, s80
    s_cbranch_scc0 L1_vs0v3
    v_pk_mul_f32 v[48:49], v[48:49], v[220:221] op_sel_hi:[1,0]
    v_pk_mul_f32 v[50:51], v[50:51], v[220:221] op_sel_hi:[1,0]
    v_pk_mul_f32 v[52:53], v[52:53], v[220:221] op_sel_hi:[1,0]
    v_pk_mul_f32 v[54:55], v[54:55], v[220:221] op_sel_hi:[1,0]
    v_pk_mul_f32 v[56:57], v[56:57], v[220:221] op_sel_hi:[1,0]
    v_pk_mul_f32 v[58:59], v[58:59], v[220:221] op_sel_hi:[1,0]
    v_pk_mul_f32 v[60:61], v[60:61], v[220:221] op_sel_hi:[1,0]
    v_pk_mul_f32 v[62:63], v[62:63], v[220:221] op_sel_hi:[1,0]
    v_pk_mul_f32 v[64:65], v[64:65], v[220:221] op_sel_hi:[1,0]
    v_pk_mul_f32 v[66:67], v[66:67], v[220:221] op_sel_hi:[1,0]
    v_pk_mul_f32 v[68:69], v[68:69], v[220:221] op_sel_hi:[1,0]
    v_pk_mul_f32 v[70:71], v[70:71], v[220:221] op_sel_hi:[1,0]
    v_pk_mul_f32 v[72:73], v[72:73], v[220:221] op_sel_hi:[1,0]
    v_pk_mul_f32 v[74:75], v[74:75], v[220:221] op_sel_hi:[1,0]
    v_pk_mul_f32 v[76:77], v[76:77], v[220:221] op_sel_hi:[1,0]
    v_pk_mul_f32 v[78:79], v[78:79], v[220:221] op_sel_hi:[1,0]
L1_vs0v3:
    s_waitcnt vmcnt(16)
    buffer_load_dwordx4 v[176:179], v2, s[24:27], 0 offen offset:0 nt
    v_perm_b32 v32, v84, v80, s44
    v_perm_b32 v33, v92, v88, s44
    v_perm_b32 v34, v100, v96, s44
    v_perm_b32 v35, v108, v104, s44
    v_perm_b32 v36, v84, v80, s45
    v_perm_b32 v37, v92, v88, s45
    v_perm_b32 v38, v100, v96, s45
    v_perm_b32 v39, v108, v104, s45
    v_mfma_f32_16x16x32_bf16 v[48:51], v[32:35], v[212:215], v[48:51]
    buffer_load_dwordx4 v[180:183], v2, s[24:27], 0 offen offset:1024 nt
    v_perm_b32 v32, v85, v81, s44
    v_perm_b32 v33, v93, v89, s44
    v_perm_b32 v34, v101, v97, s44
    v_perm_b32 v35, v109, v105, s44
    v_mfma_f32_16x16x32_bf16 v[52:55], v[36:39], v[212:215], v[52:55]
    buffer_load_dwordx4 v[184:187], v2, s[24:27], 0 offen offset:2048 nt
    v_perm_b32 v36, v85, v81, s45
    v_perm_b32 v37, v93, v89, s45
    v_perm_b32 v38, v101, v97, s45
    v_perm_b32 v39, v109, v105, s45
    v_mfma_f32_16x16x32_bf16 v[56:59], v[32:35], v[212:215], v[56:59]
    buffer_load_dwordx4 v[188:191], v2, s[24:27], 0 offen offset:3072 nt
    v_perm_b32 v32, v86, v82, s44
    v_perm_b32 v33, v94, v90, s44
    v_perm_b32 v34, v102, v98, s44
    v_perm_b32 v35, v110, v106, s44
    v_mfma_f32_16x16x32_bf16 v[60:63], v[36:39], v[212:215], v[60:63]
    buffer_load_dwordx4 v[192:195], v2, s[24:27], s52 offen offset:0 nt
    v_perm_b32 v36, v86, v82, s45
    v_perm_b32 v37, v94, v90, s45
    v_perm_b32 v38, v102, v98, s45
    v_perm_b32 v39, v110, v106, s45
    v_mfma_f32_16x16x32_bf16 v[64:67], v[32:35], v[212:215], v[64:67]
    buffer_load_dwordx4 v[196:199], v2, s[24:27], s52 offen offset:1024 nt
    v_perm_b32 v32, v87, v83, s44
    v_perm_b32 v33, v95, v91, s44
    v_perm_b32 v34, v103, v99, s44
    v_perm_b32 v35, v111, v107, s44
    v_mfma_f32_16x16x32_bf16 v[68:71], v[36:39], v[212:215], v[68:71]
    buffer_load_dwordx4 v[200:203], v2, s[24:27], s52 offen offset:2048 nt
    v_perm_b32 v36, v87, v83, s45
    v_perm_b32 v37, v95, v91, s45
    v_perm_b32 v38, v103, v99, s45
    v_perm_b32 v39, v111, v107, s45
    v_mfma_f32_16x16x32_bf16 v[72:75], v[32:35], v[212:215], v[72:75]
    buffer_load_dwordx4 v[204:207], v2, s[24:27], s52 offen offset:3072 nt
    v_add_u32 v2, 0x4000, v2
    v_mfma_f32_16x16x32_bf16 v[76:79], v[36:39], v[212:215], v[76:79]
    s_waitcnt lgkmcnt(0)
    ds_read_b128 v[212:215], v209 offset:1024
    ds_read_b32 v220, v210 offset:46144
    s_add_u32 s80, s80, s80
    s_cbranch_scc0 L1_vs1v3
    v_pk_mul_f32 v[48:49], v[48:49], v[222:223] op_sel_hi:[1,0]
    v_pk_mul_f32 v[50:51], v[50:51], v[222:223] op_sel_hi:[1,0]
    v_pk_mul_f32 v[52:53], v[52:53], v[222:223] op_sel_hi:[1,0]
    v_pk_mul_f32 v[54:55], v[54:55], v[222:223] op_sel_hi:[1,0]
    v_pk_mul_f32 v[56:57], v[56:57], v[222:223] op_sel_hi:[1,0]
    v_pk_mul_f32 v[58:59], v[58:59], v[222:223] op_sel_hi:[1,0]
    v_pk_mul_f32 v[60:61], v[60:61], v[222:223] op_sel_hi:[1,0]
    v_pk_mul_f32 v[62:63], v[62:63], v[222:223] op_sel_hi:[1,0]
    v_pk_mul_f32 v[64:65], v[64:65], v[222:223] op_sel_hi:[1,0]
    v_pk_mul_f32 v[66:67], v[66:67], v[222:223] op_sel_hi:[1,0]
    v_pk_mul_f32 v[68:69], v[68:69], v[222:223] op_sel_hi:[1,0]
    v_pk_mul_f32 v[70:71], v[70:71], v[222:223] op_sel_hi:[1,0]
    v_pk_mul_f32 v[72:73], v[72:73], v[222:223] op_sel_hi:[1,0]
    v_pk_mul_f32 v[74:75], v[74:75], v[222:223] op_sel_hi:[1,0]
    v_pk_mul_f32 v[76:77], v[76:77], v[222:223] op_sel_hi:[1,0]
    v_pk_mul_f32 v[78:79], v[78:79], v[222:223] op_sel_hi:[1,0]
L1_vs1v3:
    s_waitcnt vmcnt(16)
    v_perm_b32 v32, v116, v112, s44
    v_perm_b32 v33, v124, v120, s44
    v_perm_b32 v34, v132, v128, s44
    v_perm_b32 v35, v140, v136, s44
    v_perm_b32 v36, v116, v112, s45
    v_perm_b32 v37, v124, v120, s45
    v_perm_b32 v38, v132, v128, s45
    v_perm_b32 v39, v140, v136, s45
    v_mfma_f32_16x16x32_bf16 v[48:51], v[32:35], v[216:219], v[48:51]
    v_perm_b32 v32, v117, v113, s44
    v_perm_b32 v33, v125, v121, s44
    v_perm_b32 v34, v133, v129, s44
    v_perm_b32 v35, v141, v137, s44
    v_mfma_f32_16x16x32_bf16 v[52:55], v[36:39], v[216:219], v[52:55]
    v_perm_b32 v36, v117, v113, s45
    v_perm_b32 v37, v125, v121, s45
    v_perm_b32 v38, v133, v129, s45
    v_perm_b32 v39, v141, v137, s45
    v_mfma_f32_16x16x32_bf16 v[56:59], v[32:35], v[216:219], v[56:59]
    v_perm_b32 v32, v118, v114, s44
    v_perm_b32 v33, v126, v122, s44
    v_perm_b32 v34, v134, v130, s44
    v_perm_b32 v35, v142, v138, s44
    v_mfma_f32_16x16x32_bf16 v[60:63], v[36:39], v[216:219], v[60:63]
    v_perm_b32 v36, v118, v114, s45
    v_perm_b32 v37, v126, v122, s45
    v_perm_b32 v38, v134, v130, s45
    v_perm_b32 v39, v142, v138, s45
    v_mfma_f32_16x16x32_bf16 v[64:67], v[32:35], v[216:219], v[64:67]
    v_perm_b32 v32, v119, v115, s44
    v_perm_b32 v33, v127, v123, s44
    v_perm_b32 v34, v135, v131, s44
    v_perm_b32 v35, v143, v139, s44
    v_mfma_f32_16x16x32_bf16 v[68:71], v[36:39], v[216:219], v[68:71]
    v_perm_b32 v36, v119, v115, s45
    v_perm_b32 v37, v127, v123, s45
    v_perm_b32 v38, v135, v131, s45
    v_perm_b32 v39, v143, v139, s45
    v_mfma_f32_16x16x32_bf16 v[72:75], v[32:35], v[216:219], v[72:75]
    s_nop 0
    s_nop 0
    v_mfma_f32_16x16x32_bf16 v[76:79], v[36:39], v[216:219], v[76:79]
    s_waitcnt lgkmcnt(0)
    ds_read_b128 v[216:219], v209 offset:1536
    ds_read_b32 v222, v210 offset:46176
    s_add_u32 s80, s80, s80
    s_cbranch_scc0 L1_vs2v3
    v_pk_mul_f32 v[48:49], v[48:49], v[220:221] op_sel_hi:[1,0]
    v_pk_mul_f32 v[50:51], v[50:51], v[220:221] op_sel_hi:[1,0]
    v_pk_mul_f32 v[52:53], v[52:53], v[220:221] op_sel_hi:[1,0]
    v_pk_mul_f32 v[54:55], v[54:55], v[220:221] op_sel_hi:[1,0]
    v_pk_mul_f32 v[56:57], v[56:57], v[220:221] op_sel_hi:[1,0]
    v_pk_mul_f32 v[58:59], v[58:59], v[220:221] op_sel_hi:[1,0]
    v_pk_mul_f32 v[60:61], v[60:61], v[220:221] op_sel_hi:[1,0]
    v_pk_mul_f32 v[62:63], v[62:63], v[220:221] op_sel_hi:[1,0]
    v_pk_mul_f32 v[64:65], v[64:65], v[220:221] op_sel_hi:[1,0]
    v_pk_mul_f32 v[66:67], v[66:67], v[220:221] op_sel_hi:[1,0]
    v_pk_mul_f32 v[68:69], v[68:69], v[220:221] op_sel_hi:[1,0]
    v_pk_mul_f32 v[70:71], v[70:71], v[220:221] op_sel_hi:[1,0]
    v_pk_mul_f32 v[72:73], v[72:73], v[220:221] op_sel_hi:[1,0]
    v_pk_mul_f32 v[74:75], v[74:75], v[220:221] op_sel_hi:[1,0]
    v_pk_mul_f32 v[76:77], v[76:77], v[220:221] op_sel_hi:[1,0]
    v_pk_mul_f32 v[78:79], v[78:79], v[220:221] op_sel_hi:[1,0]
L1_vs2v3:
    s_waitcnt vmcnt(8)
    v_perm_b32 v32, v148, v144, s44
    v_perm_b32 v33, v156, v152, s44
    v_perm_b32 v34, v164, v160, s44
    v_perm_b32 v35, v172, v168, s44
    v_perm_b32 v36, v148, v144, s45
    v_perm_b32 v37, v156, v152, s45
    v_perm_b32 v38, v164, v160, s45
    v_perm_b32 v39, v172, v168, s45
    v_mfma_f32_16x16x32_bf16 v[48:51], v[32:35], v[212:215], v[48:51]
    v_perm_b32 v32, v149, v145, s44
    v_perm_b32 v33, v157, v153, s44
    v_perm_b32 v34, v165, v161, s44
    v_perm_b32 v35, v173, v169, s44
    v_mfma_f32_16x16x32_bf16 v[52:55], v[36:39], v[212:215], v[52:55]
    v_perm_b32 v36, v149, v145, s45
    v_perm_b32 v37, v157, v153, s45
    v_perm_b32 v38, v165, v161, s45
    v_perm_b32 v39, v173, v169, s45
    v_mfma_f32_16x16x32_bf16 v[56:59], v[32:35], v[212:215], v[56:59]
    v_perm_b32 v32, v150, v146, s44
    v_perm_b32 v33, v158, v154, s44
    v_perm_b32 v34, v166, v162, s44
    v_perm_b32 v35, v174, v170, s44
    v_mfma_f32_16x16x32_bf16 v[60:63], v[36:39], v[212:215], v[60:63]
    v_perm_b32 v36, v150, v146, s45
    v_perm_b32 v37, v158, v154, s45
    v_perm_b32 v38, v166, v162, s45
    v_perm_b32 v39, v174, v170, s45
    v_mfma_f32_16x16x32_bf16 v[64:67], v[32:35], v[212:215], v[64:67]
    v_perm_b32 v32, v151, v147, s44
    v_perm_b32 v33, v159, v155, s44
    v_perm_b32 v34, v167, v163, s44
    v_perm_b32 v35, v175, v171, s44
    v_mfma_f32_16x16x32_bf16 v[68:71], v[36:39], v[212:215], v[68:71]
    v_perm_b32 v36, v151, v147, s45
    v_perm_b32 v37, v159, v155, s45
    v_perm_b32 v38, v167, v163, s45
    v_perm_b32 v39, v175, v171, s45
    v_mfma_f32_16x16x32_bf16 v[72:75], v[32:35], v[212:215], v[72:75]
    s_nop 0
    s_nop 0
    v_mfma_f32_16x16x32_bf16 v[76:79], v[36:39], v[212:215], v[76:79]
L1_lt:
    s_waitcnt lgkmcnt(0)
    ds_read_b128 v[112:115], v211 offset:0
    ds_read_b128 v[116:119], v211 offset:1024
    ds_read_b128 v[120:123], v211 offset:2048
    ds_read_b128 v[124:127], v211 offset:3072
    ds_read_b128 v[128:131], v211 offset:4096
    ds_read_b128 v[132:135], v211 offset:5120
    ds_read_b128 v[136:139], v211 offset:6144
    ds_read_b128 v[140:143], v211 offset:7168
    v_mul_f32 v222, v222, v28
    v_lshlrev_b32 v12, 16, v216
    v_and_b32 v13, 0xffff0000, v216
    v_lshlrev_b32 v14, 16, v217
    v_and_b32 v15, 0xffff0000, v217
    v_lshlrev_b32 v16, 16, v218
    v_and_b32 v17, 0xffff0000, v218
    v_lshlrev_b32 v18, 16, v219
    v_and_b32 v19, 0xffff0000, v219
    v_pk_mul_f32 v[12:13], v[12:13], v[28:29] op_sel_hi:[1,0]
    v_pk_mul_f32 v[14:15], v[14:15], v[28:29] op_sel_hi:[1,0]
    v_pk_mul_f32 v[16:17], v[16:17], v[28:29] op_sel_hi:[1,0]
    v_pk_mul_f32 v[18:19], v[18:19], v[28:29] op_sel_hi:[1,0]
    v_cvt_pk_bf16_f32 v216, v12, v13
    v_cvt_pk_bf16_f32 v217, v14, v15
    v_cvt_pk_bf16_f32 v218, v16, v17
    v_cvt_pk_bf16_f32 v219, v18, v19
    v_pk_mul_f32 v[48:49], v[48:49], v[222:223] op_sel_hi:[1,0]
    v_pk_mul_f32 v[50:51], v[50:51], v[222:223] op_sel_hi:[1,0]
    v_pk_mul_f32 v[52:53], v[52:53], v[222:223] op_sel_hi:[1,0]
    v_pk_mul_f32 v[54:55], v[54:55], v[222:223] op_sel_hi:[1,0]
    v_pk_mul_f32 v[56:57], v[56:57], v[222:223] op_sel_hi:[1,0]
    v_pk_mul_f32 v[58:59], v[58:59], v[222:223] op_sel_hi:[1,0]
    v_pk_mul_f32 v[60:61], v[60:61], v[222:223] op_sel_hi:[1,0]
    v_pk_mul_f32 v[62:63], v[62:63], v[222:223] op_sel_hi:[1,0]
    v_pk_mul_f32 v[64:65], v[64:65], v[222:223] op_sel_hi:[1,0]
    v_pk_mul_f32 v[66:67], v[66:67], v[222:223] op_sel_hi:[1,0]
    v_pk_mul_f32 v[68:69], v[68:69], v[222:223] op_sel_hi:[1,0]
    v_pk_mul_f32 v[70:71], v[70:71], v[222:223] op_sel_hi:[1,0]
    v_pk_mul_f32 v[72:73], v[72:73], v[222:223] op_sel_hi:[1,0]
    v_pk_mul_f32 v[74:75], v[74:75], v[222:223] op_sel_hi:[1,0]
    v_pk_mul_f32 v[76:77], v[76:77], v[222:223] op_sel_hi:[1,0]
    v_pk_mul_f32 v[78:79], v[78:79], v[222:223] op_sel_hi:[1,0]
    ds_read_b128 v[144:147], v211 offset:8192
    ds_read_b128 v[148:151], v211 offset:9216
    ds_read_b128 v[152:155], v211 offset:10240
    ds_read_b128 v[156:159], v211 offset:11264
    ds_read_b128 v[160:163], v211 offset:12288
    ds_read_b128 v[164:167], v211 offset:13312
    ds_read_b128 v[168:171], v211 offset:14336
    ds_read_b128 v[172:175], v211 offset:15360
    s_waitcnt vmcnt(6)
    v_perm_b32 v80, v180, v176, s44
    v_perm_b32 v84, v180, v176, s45
    v_perm_b32 v88, v181, v177, s44
    v_perm_b32 v92, v181, v177, s45
    v_perm_b32 v96, v182, v178, s44
    v_perm_b32 v100, v182, v178, s45
    v_perm_b32 v104, v183, v179, s44
    v_perm_b32 v108, v183, v179, s45
    s_waitcnt vmcnt(4)
    v_perm_b32 v81, v188, v184, s44
    v_perm_b32 v85, v188, v184, s45
    v_perm_b32 v89, v189, v185, s44
    v_perm_b32 v93, v189, v185, s45
    v_perm_b32 v97, v190, v186, s44
    v_perm_b32 v101, v190, v186, s45
    v_perm_b32 v105, v191, v187, s44
    v_perm_b32 v109, v191, v187, s45
    s_waitcnt vmcnt(2)
    v_perm_b32 v82, v196, v192, s44
    v_perm_b32 v86, v196, v192, s45
    v_perm_b32 v90, v197, v193, s44
    v_perm_b32 v94, v197, v193, s45
    v_perm_b32 v98, v198, v194, s44
    v_perm_b32 v102, v198, v194, s45
    v_perm_b32 v106, v199, v195, s44
    v_perm_b32 v110, v199, v195, s45
    s_waitcnt vmcnt(0)
    v_perm_b32 v83, v204, v200, s44
    v_perm_b32 v87, v204, v200, s45
    v_perm_b32 v91, v205, v201, s44
    v_mfma_f32_16x16x32_bf16 v[48:51], v[80:83], v[216:219], v[48:51]
    v_perm_b32 v95, v205, v201, s45
    v_mfma_f32_16x16x32_bf16 v[52:55], v[84:87], v[216:219], v[52:55]
    v_perm_b32 v99, v206, v202, s44
    v_mfma_f32_16x16x32_bf16 v[56:59], v[88:91], v[216:219], v[56:59]
    v_perm_b32 v103, v206, v202, s45
    v_mfma_f32_16x16x32_bf16 v[60:63], v[92:95], v[216:219], v[60:63]
    v_perm_b32 v107, v207, v203, s44
    v_mfma_f32_16x16x32_bf16 v[64:67], v[96:99], v[216:219], v[64:67]
    v_perm_b32 v111, v207, v203, s45
    v_mfma_f32_16x16x32_bf16 v[68:71], v[100:103], v[216:219], v[68:71]
    v_cvt_pk_bf16_f32 v12, v48, v49
    v_cvt_pk_bf16_f32 v16, v50, v51
    v_cvt_pk_bf16_f32 v13, v52, v53
    v_mfma_f32_16x16x32_bf16 v[72:75], v[104:107], v[216:219], v[72:75]
    v_cvt_pk_bf16_f32 v17, v54, v55
    v_cvt_pk_bf16_f32 v14, v56, v57
    v_cvt_pk_bf16_f32 v18, v58, v59
    v_mfma_f32_16x16x32_bf16 v[76:79], v[108:111], v[216:219], v[76:79]
    s_mov_b64 exec, s[60:61]
    v_cvt_pk_bf16_f32 v15, v60, v61
    ds_write_b128 v1, v[12:15] offset:25088
    v_cvt_pk_bf16_f32 v19, v62, v63
    ds_write_b128 v1, v[16:19] offset:25120
    v_cvt_pk_bf16_f32 v20, v64, v65
    v_cvt_pk_bf16_f32 v21, v68, v69
    v_cvt_pk_bf16_f32 v22, v72, v73
    v_cvt_pk_bf16_f32 v24, v66, v67
    v_cvt_pk_bf16_f32 v23, v76, v77
    ds_write_b128 v1, v[20:23] offset:25344
    v_cvt_pk_bf16_f32 v25, v70, v71
    v_cvt_pk_bf16_f32 v26, v74, v75
    v_cvt_pk_bf16_f32 v27, v78, v79
    ds_write_b128 v1, v[24:27] offset:25376
    s_mov_b64 exec, -1
    s_waitcnt lgkmcnt(0)
    s_barrier
    ds_read_b128 v[48:51], v208 offset:29184
    ds_read_b128 v[52:55], v208 offset:30208
    ds_read_b128 v[56:59], v208 offset:31232
    ds_read_b128 v[60:63], v208 offset:32256
    v_mov_b32 v64, 0
    v_mov_b32 v65, 0
    v_mov_b32 v66, 0
    v_mov_b32 v67, 0
    v_mov_b32 v68, 0
    v_mov_b32 v69, 0
    v_mov_b32 v70, 0
    v_mov_b32 v71, 0
    s_nop 0
    s_waitcnt lgkmcnt(3)
    v_smfmac_f32_16x16x64_bf16 v[64:67], v[48:51], v[112:119], v4
    v_smfmac_f32_16x16x64_bf16 v[68:71], v[48:51], v[144:151], v4
    s_waitcnt lgkmcnt(2)
    v_smfmac_f32_16x16x64_bf16 v[64:67], v[52:55], v[120:127], v4
    v_smfmac_f32_16x16x64_bf16 v[68:71], v[52:55], v[152:159], v4
    s_waitcnt lgkmcnt(1)
    v_smfmac_f32_16x16x64_bf16 v[64:67], v[56:59], v[128:135], v4
    v_smfmac_f32_16x16x64_bf16 v[68:71], v[56:59], v[160:167], v4
    s_waitcnt lgkmcnt(0)
    v_smfmac_f32_16x16x64_bf16 v[64:67], v[60:63], v[136:143], v4
    v_smfmac_f32_16x16x64_bf16 v[68:71], v[60:63], v[168:175], v4
    s_nop 6
    v_pk_add_f32 v[64:65], v[64:65], v[66:67]
    v_pk_add_f32 v[68:69], v[68:69], v[70:71]
    v_add_f32 v64, v64, v65
    v_add_f32 v68, v68, v69
    v_cvt_pk_bf16_f32 v64, v64, v68
    buffer_store_dword v64, v3, s[40:43], s36 offen offset:8
    s_endpgm
L1_vj:
    v_add_u32 v209, 2048, v209
    v_add_u32 v210, 128, v210
    s_sub_u32 s50, s50, 1
    s_and_b32 s53, s50, 7
    s_cbranch_scc1 L1_vloop
    s_mov_b64 exec, s[60:61]
    s_cmp_lg_u32 s50, 0
    v_pk_mul_f32 v[48:49], v[48:49], v[28:29] op_sel_hi:[1,0]
    v_pk_mul_f32 v[52:53], v[52:53], v[28:29] op_sel_hi:[1,0]
    v_pk_mul_f32 v[56:57], v[56:57], v[28:29] op_sel_hi:[1,0]
    v_pk_mul_f32 v[60:61], v[60:61], v[28:29] op_sel_hi:[1,0]
    v_cvt_pk_bf16_f32 v12, v48, v49
    v_cvt_pk_bf16_f32 v13, v52, v53
    v_cvt_pk_bf16_f32 v14, v56, v57
    v_cvt_pk_bf16_f32 v15, v60, v61
    ds_write_b128 v1, v[12:15] offset:25088
    v_pk_mul_f32 v[50:51], v[50:51], v[28:29] op_sel_hi:[1,0]
    v_pk_mul_f32 v[54:55], v[54:55], v[28:29] op_sel_hi:[1,0]
    v_pk_mul_f32 v[58:59], v[58:59], v[28:29] op_sel_hi:[1,0]
    v_pk_mul_f32 v[62:63], v[62:63], v[28:29] op_sel_hi:[1,0]
    v_cvt_pk_bf16_f32 v16, v50, v51
    v_cvt_pk_bf16_f32 v17, v54, v55
    v_cvt_pk_bf16_f32 v18, v58, v59
    v_cvt_pk_bf16_f32 v19, v62, v63
    ds_write_b128 v1, v[16:19] offset:25120
    v_pk_mul_f32 v[64:65], v[64:65], v[28:29] op_sel_hi:[1,0]
    v_pk_mul_f32 v[68:69], v[68:69], v[28:29] op_sel_hi:[1,0]
    v_pk_mul_f32 v[72:73], v[72:73], v[28:29] op_sel_hi:[1,0]
    v_pk_mul_f32 v[76:77], v[76:77], v[28:29] op_sel_hi:[1,0]
    v_cvt_pk_bf16_f32 v20, v64, v65
    v_cvt_pk_bf16_f32 v21, v68, v69
    v_cvt_pk_bf16_f32 v22, v72, v73
    v_cvt_pk_bf16_f32 v23, v76, v77
    ds_write_b128 v1, v[20:23] offset:25344
    v_pk_mul_f32 v[66:67], v[66:67], v[28:29] op_sel_hi:[1,0]
    v_pk_mul_f32 v[70:71], v[70:71], v[28:29] op_sel_hi:[1,0]
    v_pk_mul_f32 v[74:75], v[74:75], v[28:29] op_sel_hi:[1,0]
    v_pk_mul_f32 v[78:79], v[78:79], v[28:29] op_sel_hi:[1,0]
    v_cvt_pk_bf16_f32 v24, v66, v67
    v_cvt_pk_bf16_f32 v25, v70, v71
    v_cvt_pk_bf16_f32 v26, v74, v75
    v_cvt_pk_bf16_f32 v27, v78, v79
    ds_write_b128 v1, v[24:27] offset:25376
    s_mov_b64 exec, -1
    v_add_u32 v1, 4096, v1
    v_mov_b32 v28, v30
    s_cbranch_scc1 L1_vreset
    s_waitcnt lgkmcnt(0)
    s_barrier
L1_sdone:
    s_waitcnt vmcnt(0)
    s_branch L1_fin
L1_fac:
    ds_read_b32 v7, v247 offset:41728
    s_waitcnt lgkmcnt(0)
    v_cmp_eq_u32 vcc, 0, v7
    s_cbranch_vccnz L1_fac
    v_and_b32 v7, 7, v0
    s_lshl_b32 s53, s59, 6
    v_lshl_add_u32 v8, v7, 3, s53
    v_xor_b32 v3, 64, v8
    ds_read_b64 v[12:13], v8 offset:41472
    ds_read_b64 v[14:15], v3 offset:41472
    ds_read_b64 v[20:21], v8 offset:41600
    ds_read_b64 v[22:23], v3 offset:41600
    v_and_b32 v1, 4, v0
    v_add_u32 v1, v1, v10
    v_subrev_u32 v1, s49, v1
    v_and_b32 v1, 7, v1
    v_lshlrev_b32 v1, 9, v1
    v_and_b32 v7, 3, v0
    v_lshl_add_u32 v1, v7, 6, v1
    s_lshl_b32 s53, s59, 4
    v_add_u32 v1, s53, v1
    s_waitcnt lgkmcnt(0)
    v_max_f32 v16, v12, v14
    v_sub_f32 v12, v12, v16
    v_sub_f32 v14, v14, v16
    v_exp_f32 v12, v12
    v_exp_f32 v14, v14
    s_nop 0
    v_mul_f32 v13, v12, v13
    v_fma_f32 v13, v14, v15, v13
    v_rcp_f32 v13, v13
    s_nop 0
    v_mul_f32 v28, v12, v13
    v_max_f32 v24, v20, v22
    v_sub_f32 v20, v20, v24
    v_sub_f32 v22, v22, v24
    v_exp_f32 v20, v20
    v_exp_f32 v22, v22
    s_nop 0
    v_mul_f32 v21, v20, v21
    v_fma_f32 v21, v22, v23, v21
    v_rcp_f32 v21, v21
    s_nop 0
    v_mul_f32 v30, v20, v21
    s_branch L1_facret
L1_smb:
    s_waitcnt lgkmcnt(0)
    s_barrier
    v_lshlrev_b32 v208, 4, v0
    s_mul_i32 s53, s59, 56832
    s_add_u32 s53, s53, 82944
    v_add_u32 v211, s53, v208
    v_mul_u32_u24 v3, 12, v0
    v_bfe_u32 v4, v0, 1, 1
    v_mul_u32_u24 v4, 0xaaaa, v4
    v_add_u32 v4, 0x4444, v4
    s_branch L1_smbret
L1_alt0k0:
    ds_read_b128 v[176:179], v208 offset:0
    ds_read_b128 v[180:183], v208 offset:1024
    ds_read_b128 v[184:187], v208 offset:2048
    ds_read_b128 v[188:191], v208 offset:3072
    ds_read_b128 v[192:195], v208 offset:4096
    ds_read_b128 v[196:199], v208 offset:5120
    ds_read_b128 v[200:203], v208 offset:6144
    ds_read_b128 v[204:207], v208 offset:7168
    v_add_u32 v208, 0x2000, v208
    v_add_u32 v1, 0x4000, v1
    s_branch L1_kret0k0
L1_alt1k0:
    ds_read_b128 v[80:83], v208 offset:0
    ds_read_b128 v[84:87], v208 offset:1024
    ds_read_b128 v[88:91], v208 offset:2048
    ds_read_b128 v[92:95], v208 offset:3072
    ds_read_b128 v[96:99], v208 offset:4096
    ds_read_b128 v[100:103], v208 offset:5120
    ds_read_b128 v[104:107], v208 offset:6144
    ds_read_b128 v[108:111], v208 offset:7168
    v_add_u32 v208, 0x2000, v208
    v_add_u32 v1, 0x4000, v1
    s_branch L1_kret1k0
L1_alt2k0:
    ds_read_b128 v[112:115], v208 offset:0
    ds_read_b128 v[116:119], v208 offset:1024
    ds_read_b128 v[120:123], v208 offset:2048
    ds_read_b128 v[124:127], v208 offset:3072
    ds_read_b128 v[128:131], v208 offset:4096
    ds_read_b128 v[132:135], v208 offset:5120
    ds_read_b128 v[136:139], v208 offset:6144
    ds_read_b128 v[140:143], v208 offset:7168
    v_add_u32 v208, 0x2000, v208
    v_add_u32 v1, 0x4000, v1
    s_branch L1_kret2k0
L1_alt3k0:
    ds_read_b128 v[144:147], v208 offset:0
    ds_read_b128 v[148:151], v208 offset:1024
    ds_read_b128 v[152:155], v208 offset:2048
    ds_read_b128 v[156:159], v208 offset:3072
    ds_read_b128 v[160:163], v208 offset:4096
    ds_read_b128 v[164:167], v208 offset:5120
    ds_read_b128 v[168:171], v208 offset:6144
    ds_read_b128 v[172:175], v208 offset:7168
    v_add_u32 v208, 0x2000, v208
    v_add_u32 v1, 0x4000, v1
    s_branch L1_kret3k0
L1_kv1k0:
    s_waitcnt vmcnt(10)
    buffer_load_dwordx4 v[80:83], v2, s[24:27], 0 offen offset:0 nt
    s_waitcnt vmcnt(10)
    buffer_load_dwordx4 v[84:87], v2, s[24:27], 0 offen offset:1024 nt
    s_waitcnt vmcnt(10)
    buffer_load_dwordx4 v[88:91], v2, s[24:27], 0 offen offset:2048 nt
    s_waitcnt vmcnt(10)
    buffer_load_dwordx4 v[92:95], v2, s[24:27], 0 offen offset:3072 nt
    s_waitcnt vmcnt(10)
    buffer_load_dwordx4 v[96:99], v2, s[24:27], s52 offen offset:0 nt
    s_waitcnt vmcnt(10)
    buffer_load_dwordx4 v[100:103], v2, s[24:27], s52 offen offset:1024 nt
    s_waitcnt vmcnt(10)
    buffer_load_dwordx4 v[104:107], v2, s[24:27], s52 offen offset:2048 nt
    s_waitcnt vmcnt(10)
    buffer_load_dwordx4 v[108:111], v2, s[24:27], s52 offen offset:3072 nt
    v_add_u32 v2, 0x4000, v2
    s_branch L1_kret1k0
L1_kv2k0:
    s_waitcnt vmcnt(10)
    buffer_load_dwordx4 v[112:115], v2, s[24:27], 0 offen offset:0 nt
    s_waitcnt vmcnt(10)
    buffer_load_dwordx4 v[116:119], v2, s[24:27], 0 offen offset:1024 nt
    s_waitcnt vmcnt(10)
    buffer_load_dwordx4 v[120:123], v2, s[24:27], 0 offen offset:2048 nt
    s_waitcnt vmcnt(10)
    buffer_load_dwordx4 v[124:127], v2, s[24:27], 0 offen offset:3072 nt
    s_waitcnt vmcnt(10)
    buffer_load_dwordx4 v[128:131], v2, s[24:27], s52 offen offset:0 nt
    s_waitcnt vmcnt(10)
    buffer_load_dwordx4 v[132:135], v2, s[24:27], s52 offen offset:1024 nt
    s_waitcnt vmcnt(10)
    buffer_load_dwordx4 v[136:139], v2, s[24:27], s52 offen offset:2048 nt
    s_waitcnt vmcnt(10)
    buffer_load_dwordx4 v[140:143], v2, s[24:27], s52 offen offset:3072 nt
    v_add_u32 v2, 0x4000, v2
    s_branch L1_kret2k0
L1_kv3k0:
    s_waitcnt vmcnt(10)
    buffer_load_dwordx4 v[144:147], v2, s[24:27], 0 offen offset:0 nt
    s_waitcnt vmcnt(10)
    buffer_load_dwordx4 v[148:151], v2, s[24:27], 0 offen offset:1024 nt
    s_waitcnt vmcnt(10)
    buffer_load_dwordx4 v[152:155], v2, s[24:27], 0 offen offset:2048 nt
    s_waitcnt vmcnt(10)
    buffer_load_dwordx4 v[156:159], v2, s[24:27], 0 offen offset:3072 nt
    s_waitcnt vmcnt(10)
    buffer_load_dwordx4 v[160:163], v2, s[24:27], s52 offen offset:0 nt
    s_waitcnt vmcnt(10)
    buffer_load_dwordx4 v[164:167], v2, s[24:27], s52 offen offset:1024 nt
    s_waitcnt vmcnt(10)
    buffer_load_dwordx4 v[168:171], v2, s[24:27], s52 offen offset:2048 nt
    s_waitcnt vmcnt(10)
    buffer_load_dwordx4 v[172:175], v2, s[24:27], s52 offen offset:3072 nt
    v_add_u32 v2, 0x4000, v2
    s_branch L1_kret3k0
L1_alt0k1:
    ds_read_b128 v[176:179], v208 offset:0
    ds_read_b128 v[180:183], v208 offset:1024
    ds_read_b128 v[184:187], v208 offset:2048
    ds_read_b128 v[188:191], v208 offset:3072
    ds_read_b128 v[192:195], v208 offset:4096
    ds_read_b128 v[196:199], v208 offset:5120
    ds_read_b128 v[200:203], v208 offset:6144
    ds_read_b128 v[204:207], v208 offset:7168
    v_add_u32 v208, 0x2000, v208
    v_add_u32 v1, 0x4000, v1
    s_branch L1_kret0k1
L1_alt1k1:
    ds_read_b128 v[80:83], v208 offset:0
    ds_read_b128 v[84:87], v208 offset:1024
    ds_read_b128 v[88:91], v208 offset:2048
    ds_read_b128 v[92:95], v208 offset:3072
    ds_read_b128 v[96:99], v208 offset:4096
    ds_read_b128 v[100:103], v208 offset:5120
    ds_read_b128 v[104:107], v208 offset:6144
    ds_read_b128 v[108:111], v208 offset:7168
    v_add_u32 v208, 0x2000, v208
    v_add_u32 v1, 0x4000, v1
    s_branch L1_kret1k1
L1_alt2k1:
    ds_read_b128 v[112:115], v208 offset:0
    ds_read_b128 v[116:119], v208 offset:1024
    ds_read_b128 v[120:123], v208 offset:2048
    ds_read_b128 v[124:127], v208 offset:3072
    ds_read_b128 v[128:131], v208 offset:4096
    ds_read_b128 v[132:135], v208 offset:5120
    ds_read_b128 v[136:139], v208 offset:6144
    ds_read_b128 v[140:143], v208 offset:7168
    v_add_u32 v208, 0x2000, v208
    v_add_u32 v1, 0x4000, v1
    s_branch L1_kret2k1
L1_alt3k1:
    ds_read_b128 v[144:147], v208 offset:0
    ds_read_b128 v[148:151], v208 offset:1024
    ds_read_b128 v[152:155], v208 offset:2048
    ds_read_b128 v[156:159], v208 offset:3072
    ds_read_b128 v[160:163], v208 offset:4096
    ds_read_b128 v[164:167], v208 offset:5120
    ds_read_b128 v[168:171], v208 offset:6144
    ds_read_b128 v[172:175], v208 offset:7168
    v_add_u32 v208, 0x2000, v208
    v_add_u32 v1, 0x4000, v1
    s_branch L1_kret3k1
L1_kv1k1:
    buffer_load_dwordx4 v[80:83], v2, s[24:27], 0 offen offset:0 nt
    buffer_load_dwordx4 v[84:87], v2, s[24:27], 0 offen offset:1024 nt
    buffer_load_dwordx4 v[88:91], v2, s[24:27], 0 offen offset:2048 nt
    buffer_load_dwordx4 v[92:95], v2, s[24:27], 0 offen offset:3072 nt
    buffer_load_dwordx4 v[96:99], v2, s[24:27], s52 offen offset:0 nt
    buffer_load_dwordx4 v[100:103], v2, s[24:27], s52 offen offset:1024 nt
    buffer_load_dwordx4 v[104:107], v2, s[24:27], s52 offen offset:2048 nt
    buffer_load_dwordx4 v[108:111], v2, s[24:27], s52 offen offset:3072 nt
    v_add_u32 v2, 0x4000, v2
    s_branch L1_kret1k1
L1_kv2k1:
    buffer_load_dwordx4 v[112:115], v2, s[24:27], 0 offen offset:0 nt
    buffer_load_dwordx4 v[116:119], v2, s[24:27], 0 offen offset:1024 nt
    buffer_load_dwordx4 v[120:123], v2, s[24:27], 0 offen offset:2048 nt
    buffer_load_dwordx4 v[124:127], v2, s[24:27], 0 offen offset:3072 nt
    buffer_load_dwordx4 v[128:131], v2, s[24:27], s52 offen offset:0 nt
    buffer_load_dwordx4 v[132:135], v2, s[24:27], s52 offen offset:1024 nt
    buffer_load_dwordx4 v[136:139], v2, s[24:27], s52 offen offset:2048 nt
    buffer_load_dwordx4 v[140:143], v2, s[24:27], s52 offen offset:3072 nt
    v_add_u32 v2, 0x4000, v2
    s_branch L1_kret2k1
L1_kv3k1:
    buffer_load_dwordx4 v[144:147], v2, s[24:27], 0 offen offset:0 nt
    buffer_load_dwordx4 v[148:151], v2, s[24:27], 0 offen offset:1024 nt
    buffer_load_dwordx4 v[152:155], v2, s[24:27], 0 offen offset:2048 nt
    buffer_load_dwordx4 v[156:159], v2, s[24:27], 0 offen offset:3072 nt
    buffer_load_dwordx4 v[160:163], v2, s[24:27], s52 offen offset:0 nt
    buffer_load_dwordx4 v[164:167], v2, s[24:27], s52 offen offset:1024 nt
    buffer_load_dwordx4 v[168:171], v2, s[24:27], s52 offen offset:2048 nt
    buffer_load_dwordx4 v[172:175], v2, s[24:27], s52 offen offset:3072 nt
    v_add_u32 v2, 0x4000, v2
    s_branch L1_kret3k1
L1_helper:
    s_setprio 2
    s_lshr_b32 s59, s49, 1
    s_add_u32 s59, s59, s57
    s_mul_i32 s53, s59, 43
    s_lshr_b32 s53, s53, 8
    s_mul_i32 s53, s53, 6
    s_sub_u32 s59, s59, s53
    s_cmp_ge_u32 s59, 3
    s_cselect_b32 s56, 1, 0
    s_mul_i32 s53, s56, 3
    s_sub_u32 s54, s59, s53
    v_lshrrev_b32 v3, 3, v0
    v_and_b32 v4, 7, v0
    v_lshlrev_b32 v4, 4, v4
    s_mul_i32 s53, s49, 9216
    s_mul_i32 s55, s54, 384
    s_add_u32 s53, s53, s55
    v_mul_u32_u24 v2, 1152, v3
    v_add3_u32 v2, v2, v4, s53
    s_mul_i32 s53, s49, 43
    s_lshr_b32 s53, s53, 8
    s_mul_i32 s53, s53, 6
    s_sub_u32 s58, s49, s53
    v_lshlrev_b32 v1, 16, v10
    v_lshl_add_u32 v1, v9, 4, v1
    s_lshl_b32 s55, s48, 9
    s_lshl_b32 s53, s56, 8
    s_add_u32 s55, s55, s53
    s_mul_i32 s53, s54, 1572864
    s_add_u32 s55, s55, s53
    v_add_u32 v1, s55, v1
    s_lshl_b32 s51, s54, 7
    s_mov_b32 s50, s58
    s_waitcnt lgkmcnt(0)
    s_mov_b32 s36, s4
    s_mov_b32 s37, s5
    s_mov_b32 s38, 147456
    s_mov_b32 s39, 0x20000
    buffer_load_dwordx4 v[40:43], v2, s[36:39], 0 offen offset:0
    buffer_load_dwordx4 v[44:47], v2, s[36:39], 0 offen offset:128
    buffer_load_dwordx4 v[48:51], v2, s[36:39], 0 offen offset:256
    s_mov_b32 s28, s10
    s_mov_b32 s29, s11
    s_mov_b32 s30, 4718592
    s_mov_b32 s31, 0x20000
    v_lshrrev_b32 v12, 5, v0
    v_and_b32 v13, 31, v0
    v_lshlrev_b32 v12, 13, v12
    v_lshl_add_u32 v12, v13, 4, v12
    s_mul_i32 s53, s49, 6
    s_add_u32 s53, s53, s57
    s_mul_i32 s53, s53, 49152
    s_lshl_b32 s55, s48, 9
    s_add_u32 s53, s53, s55
    buffer_load_dwordx4 v[20:23], v12, s[28:31], s53 offen
    s_add_u32 s53, s53, 16384
    buffer_load_dwordx4 v[20:23], v12, s[28:31], s53 offen
    s_add_u32 s53, s53, 16384
    buffer_load_dwordx4 v[20:23], v12, s[28:31], s53 offen
    s_cmp_eq_u32 s63, 0
    s_cbranch_scc1 L1_hb
    s_barrier
L1_hb:
    s_setprio 3
    s_lshl_b32 s55, s50, 18
    buffer_load_dwordx4 v[64:67], v1, s[28:31], s55 offen
    s_add_u32 s55, s55, 8192
    buffer_load_dwordx4 v[68:71], v1, s[28:31], s55 offen
    s_add_u32 s55, s55, 8192
    buffer_load_dwordx4 v[72:75], v1, s[28:31], s55 offen
    s_add_u32 s55, s55, 8192
    buffer_load_dwordx4 v[76:79], v1, s[28:31], s55 offen
    s_add_u32 s55, s55, 8192
    buffer_load_dwordx4 v[80:83], v1, s[28:31], s55 offen
    s_add_u32 s55, s55, 8192
    buffer_load_dwordx4 v[84:87], v1, s[28:31], s55 offen
    s_add_u32 s55, s55, 8192
    buffer_load_dwordx4 v[88:91], v1, s[28:31], s55 offen
    s_add_u32 s55, s55, 8192
    buffer_load_dwordx4 v[92:95], v1, s[28:31], s55 offen
    s_add_u32 s50, s50, 1
    s_cmp_eq_u32 s50, 6
    s_cselect_b32 s50, 0, s50
    s_lshl_b32 s55, s50, 18
    buffer_load_dwordx4 v[96:99], v1, s[28:31], s55 offen
    s_add_u32 s55, s55, 8192
    buffer_load_dwordx4 v[100:103], v1, s[28:31], s55 offen
    s_add_u32 s55, s55, 8192
    buffer_load_dwordx4 v[104:107], v1, s[28:31], s55 offen
    s_add_u32 s55, s55, 8192
    buffer_load_dwordx4 v[108:111], v1, s[28:31], s55 offen
    s_add_u32 s55, s55, 8192
    buffer_load_dwordx4 v[112:115], v1, s[28:31], s55 offen
    s_add_u32 s55, s55, 8192
    buffer_load_dwordx4 v[116:119], v1, s[28:31], s55 offen
    s_add_u32 s55, s55, 8192
    buffer_load_dwordx4 v[120:123], v1, s[28:31], s55 offen
    s_add_u32 s55, s55, 8192
    buffer_load_dwordx4 v[124:127], v1, s[28:31], s55 offen
    s_add_u32 s50, s50, 1
    s_cmp_eq_u32 s50, 6
    s_cselect_b32 s50, 0, s50
    s_lshl_b32 s55, s50, 18
    buffer_load_dwordx4 v[128:131], v1, s[28:31], s55 offen
    s_add_u32 s55, s55, 8192
    buffer_load_dwordx4 v[132:135], v1, s[28:31], s55 offen
    s_add_u32 s55, s55, 8192
    buffer_load_dwordx4 v[136:139], v1, s[28:31], s55 offen
    s_add_u32 s55, s55, 8192
    buffer_load_dwordx4 v[140:143], v1, s[28:31], s55 offen
    s_add_u32 s55, s55, 8192
    buffer_load_dwordx4 v[144:147], v1, s[28:31], s55 offen
    s_add_u32 s55, s55, 8192
    buffer_load_dwordx4 v[148:151], v1, s[28:31], s55 offen
    s_add_u32 s55, s55, 8192
    buffer_load_dwordx4 v[152:155], v1, s[28:31], s55 offen
    s_add_u32 s55, s55, 8192
    buffer_load_dwordx4 v[156:159], v1, s[28:31], s55 offen
    s_add_u32 s50, s50, 1
    s_cmp_eq_u32 s50, 6
    s_cselect_b32 s50, 0, s50
    v_and_b32 v18, 31, v0
    v_mul_u32_u24 v18, 784, v18
    v_lshrrev_b32 v19, 5, v0
    v_mul_u32_u24 v19, 384, v19
    v_add_u32 v18, v18, v19
    v_add_u32 v18, s51, v18
    s_mov_b32 s60, 0x0f0f0f0f
    s_cmp_eq_u32 s56, 0
    s_cselect_b32 s60, s60, 0xf0f0f0f0
    s_mov_b32 s61, s60
    s_mul_i32 s53, s57, 3200
    v_mul_u32_u24 v5, 400, v3
    v_add3_u32 v5, v5, v4, s53
    v_bfe_u32 v3, v0, 3, 1
    v_and_b32 v4, 3, v0
    v_lshl_add_u32 v3, v3, 2, v4
    v_mul_u32_u24 v3, 400, v3
    v_lshl_add_u32 v3, v10, 4, v3
    v_add_u32 v3, s53, v3
    s_mov_b32 s54, s58
    s_lshl_b32 s53, s54, 6
    v_add_u32 v12, s53, v3
    s_add_u32 s54, s54, 1
    s_cmp_eq_u32 s54, 6
    s_cselect_b32 s54, 0, s54
    s_lshl_b32 s53, s54, 6
    v_add_u32 v13, s53, v3
    s_add_u32 s54, s54, 1
    s_cmp_eq_u32 s54, 6
    s_cselect_b32 s54, 0, s54
    s_lshl_b32 s53, s54, 6
    v_add_u32 v14, s53, v3
    s_add_u32 s54, s54, 1
    s_cmp_eq_u32 s54, 6
    s_cselect_b32 s54, 0, s54
    s_lshl_b32 s53, s54, 6
    v_add_u32 v15, s53, v3
    s_add_u32 s54, s54, 1
    s_cmp_eq_u32 s54, 6
    s_cselect_b32 s54, 0, s54
    s_lshl_b32 s53, s54, 6
    v_add_u32 v16, s53, v3
    s_add_u32 s54, s54, 1
    s_cmp_eq_u32 s54, 6
    s_cselect_b32 s54, 0, s54
    s_lshl_b32 s53, s54, 6
    v_add_u32 v17, s53, v3
    s_waitcnt vmcnt(24)
    ds_write_b128 v5, v[40:43] offset:25088
    ds_write_b128 v5, v[44:47] offset:25216
    ds_write_b128 v5, v[48:51] offset:25344
    s_waitcnt lgkmcnt(0)
    ds_read_b128 v[40:43], v12 offset:25088
    ds_read_b128 v[44:47], v13 offset:25088
    ds_read_b128 v[48:51], v14 offset:25088
    ds_read_b128 v[52:55], v15 offset:25088
    ds_read_b128 v[56:59], v16 offset:25088
    ds_read_b128 v[60:63], v17 offset:25088
    s_waitcnt vmcnt(16) lgkmcnt(0)
    v_perm_b32 v32, v68, v64, s44
    v_perm_b32 v33, v76, v72, s44
    v_perm_b32 v34, v84, v80, s44
    v_perm_b32 v35, v92, v88, s44
    v_perm_b32 v36, v68, v64, s45
    v_perm_b32 v37, v76, v72, s45
    v_perm_b32 v38, v84, v80, s45
    v_perm_b32 v39, v92, v88, s45
    v_mfma_f32_16x16x32_bf16 v[224:227], v[32:35], v[40:43], 0
    v_perm_b32 v32, v69, v65, s44
    v_perm_b32 v33, v77, v73, s44
    v_perm_b32 v34, v85, v81, s44
    v_perm_b32 v35, v93, v89, s44
    v_mfma_f32_16x16x32_bf16 v[228:231], v[36:39], v[40:43], 0
    v_perm_b32 v36, v69, v65, s45
    v_perm_b32 v37, v77, v73, s45
    v_perm_b32 v38, v85, v81, s45
    v_perm_b32 v39, v93, v89, s45
    v_mfma_f32_16x16x32_bf16 v[232:235], v[32:35], v[40:43], 0
    v_perm_b32 v32, v70, v66, s44
    v_perm_b32 v33, v78, v74, s44
    v_perm_b32 v34, v86, v82, s44
    v_perm_b32 v35, v94, v90, s44
    v_mfma_f32_16x16x32_bf16 v[236:239], v[36:39], v[40:43], 0
    v_perm_b32 v36, v70, v66, s45
    v_perm_b32 v37, v78, v74, s45
    v_perm_b32 v38, v86, v82, s45
    v_perm_b32 v39, v94, v90, s45
    v_mfma_f32_16x16x32_bf16 v[240:243], v[32:35], v[40:43], 0
    v_perm_b32 v32, v71, v67, s44
    v_perm_b32 v33, v79, v75, s44
    v_perm_b32 v34, v87, v83, s44
    v_perm_b32 v35, v95, v91, s44
    v_mfma_f32_16x16x32_bf16 v[244:247], v[36:39], v[40:43], 0
    v_perm_b32 v36, v71, v67, s45
    v_perm_b32 v37, v79, v75, s45
    v_perm_b32 v38, v87, v83, s45
    v_perm_b32 v39, v95, v91, s45
    v_mfma_f32_16x16x32_bf16 v[248:251], v[32:35], v[40:43], 0
    s_nop 0
    v_mfma_f32_16x16x32_bf16 v[252:255], v[36:39], v[40:43], 0
    s_setprio 2
    s_lshl_b32 s55, s50, 18
    buffer_load_dwordx4 v[160:163], v1, s[28:31], s55 offen
    s_add_u32 s55, s55, 8192
    buffer_load_dwordx4 v[164:167], v1, s[28:31], s55 offen
    s_add_u32 s55, s55, 8192
    buffer_load_dwordx4 v[168:171], v1, s[28:31], s55 offen
    s_add_u32 s55, s55, 8192
    buffer_load_dwordx4 v[172:175], v1, s[28:31], s55 offen
    s_add_u32 s55, s55, 8192
    buffer_load_dwordx4 v[176:179], v1, s[28:31], s55 offen
    s_add_u32 s55, s55, 8192
    buffer_load_dwordx4 v[180:183], v1, s[28:31], s55 offen
    s_add_u32 s55, s55, 8192
    buffer_load_dwordx4 v[184:187], v1, s[28:31], s55 offen
    s_add_u32 s55, s55, 8192
    buffer_load_dwordx4 v[188:191], v1, s[28:31], s55 offen
    s_add_u32 s50, s50, 1
    s_cmp_eq_u32 s50, 6
    s_cselect_b32 s50, 0, s50
    s_waitcnt vmcnt(16)
    v_perm_b32 v32, v100, v96, s44
    v_perm_b32 v33, v108, v104, s44
    v_perm_b32 v34, v116, v112, s44
    v_perm_b32 v35, v124, v120, s44
    v_perm_b32 v36, v100, v96, s45
    v_perm_b32 v37, v108, v104, s45
    v_perm_b32 v38, v116, v112, s45
    v_perm_b32 v39, v124, v120, s45
    v_mfma_f32_16x16x32_bf16 v[224:227], v[32:35], v[44:47], v[224:227]
    v_perm_b32 v32, v101, v97, s44
    v_perm_b32 v33, v109, v105, s44
    v_perm_b32 v34, v117, v113, s44
    v_perm_b32 v35, v125, v121, s44
    v_mfma_f32_16x16x32_bf16 v[228:231], v[36:39], v[44:47], v[228:231]
    v_perm_b32 v36, v101, v97, s45
    v_perm_b32 v37, v109, v105, s45
    v_perm_b32 v38, v117, v113, s45
    v_perm_b32 v39, v125, v121, s45
    v_mfma_f32_16x16x32_bf16 v[232:235], v[32:35], v[44:47], v[232:235]
    v_perm_b32 v32, v102, v98, s44
    v_perm_b32 v33, v110, v106, s44
    v_perm_b32 v34, v118, v114, s44
    v_perm_b32 v35, v126, v122, s44
    v_mfma_f32_16x16x32_bf16 v[236:239], v[36:39], v[44:47], v[236:239]
    v_perm_b32 v36, v102, v98, s45
    v_perm_b32 v37, v110, v106, s45
    v_perm_b32 v38, v118, v114, s45
    v_perm_b32 v39, v126, v122, s45
    v_mfma_f32_16x16x32_bf16 v[240:243], v[32:35], v[44:47], v[240:243]
    v_perm_b32 v32, v103, v99, s44
    v_perm_b32 v33, v111, v107, s44
    v_perm_b32 v34, v119, v115, s44
    v_perm_b32 v35, v127, v123, s44
    v_mfma_f32_16x16x32_bf16 v[244:247], v[36:39], v[44:47], v[244:247]
    v_perm_b32 v36, v103, v99, s45
    v_perm_b32 v37, v111, v107, s45
    v_perm_b32 v38, v119, v115, s45
    v_perm_b32 v39, v127, v123, s45
    v_mfma_f32_16x16x32_bf16 v[248:251], v[32:35], v[44:47], v[248:251]
    s_nop 0
    v_mfma_f32_16x16x32_bf16 v[252:255], v[36:39], v[44:47], v[252:255]
    s_lshl_b32 s55, s50, 18
    buffer_load_dwordx4 v[192:195], v1, s[28:31], s55 offen
    s_add_u32 s55, s55, 8192
    buffer_load_dwordx4 v[196:199], v1, s[28:31], s55 offen
    s_add_u32 s55, s55, 8192
    buffer_load_dwordx4 v[200:203], v1, s[28:31], s55 offen
    s_add_u32 s55, s55, 8192
    buffer_load_dwordx4 v[204:207], v1, s[28:31], s55 offen
    s_add_u32 s55, s55, 8192
    buffer_load_dwordx4 v[208:211], v1, s[28:31], s55 offen
    s_add_u32 s55, s55, 8192
    buffer_load_dwordx4 v[212:215], v1, s[28:31], s55 offen
    s_add_u32 s55, s55, 8192
    buffer_load_dwordx4 v[216:219], v1, s[28:31], s55 offen
    s_add_u32 s55, s55, 8192
    buffer_load_dwordx4 v[220:223], v1, s[28:31], s55 offen
    s_add_u32 s50, s50, 1
    s_cmp_eq_u32 s50, 6
    s_cselect_b32 s50, 0, s50
    s_waitcnt vmcnt(16)
    v_perm_b32 v32, v132, v128, s44
    v_perm_b32 v33, v140, v136, s44
    v_perm_b32 v34, v148, v144, s44
    v_perm_b32 v35, v156, v152, s44
    v_perm_b32 v36, v132, v128, s45
    v_perm_b32 v37, v140, v136, s45
    v_perm_b32 v38, v148, v144, s45
    v_perm_b32 v39, v156, v152, s45
    v_mfma_f32_16x16x32_bf16 v[224:227], v[32:35], v[48:51], v[224:227]
    v_perm_b32 v32, v133, v129, s44
    v_perm_b32 v33, v141, v137, s44
    v_perm_b32 v34, v149, v145, s44
    v_perm_b32 v35, v157, v153, s44
    v_mfma_f32_16x16x32_bf16 v[228:231], v[36:39], v[48:51], v[228:231]
    v_perm_b32 v36, v133, v129, s45
    v_perm_b32 v37, v141, v137, s45
    v_perm_b32 v38, v149, v145, s45
    v_perm_b32 v39, v157, v153, s45
    v_mfma_f32_16x16x32_bf16 v[232:235], v[32:35], v[48:51], v[232:235]
    v_perm_b32 v32, v134, v130, s44
    v_perm_b32 v33, v142, v138, s44
    v_perm_b32 v34, v150, v146, s44
    v_perm_b32 v35, v158, v154, s44
    v_mfma_f32_16x16x32_bf16 v[236:239], v[36:39], v[48:51], v[236:239]
    v_perm_b32 v36, v134, v130, s45
    v_perm_b32 v37, v142, v138, s45
    v_perm_b32 v38, v150, v146, s45
    v_perm_b32 v39, v158, v154, s45
    v_mfma_f32_16x16x32_bf16 v[240:243], v[32:35], v[48:51], v[240:243]
    v_perm_b32 v32, v135, v131, s44
    v_perm_b32 v33, v143, v139, s44
    v_perm_b32 v34, v151, v147, s44
    v_perm_b32 v35, v159, v155, s44
    v_mfma_f32_16x16x32_bf16 v[244:247], v[36:39], v[48:51], v[244:247]
    v_perm_b32 v36, v135, v131, s45
    v_perm_b32 v37, v143, v139, s45
    v_perm_b32 v38, v151, v147, s45
    v_perm_b32 v39, v159, v155, s45
    v_mfma_f32_16x16x32_bf16 v[248:251], v[32:35], v[48:51], v[248:251]
    s_nop 0
    v_mfma_f32_16x16x32_bf16 v[252:255], v[36:39], v[48:51], v[252:255]
    s_setprio 1
    s_lshl_b32 s55, s50, 18
    buffer_load_dwordx4 v[64:67], v1, s[28:31], s55 offen
    s_add_u32 s55, s55, 8192
    buffer_load_dwordx4 v[68:71], v1, s[28:31], s55 offen
    s_add_u32 s55, s55, 8192
    buffer_load_dwordx4 v[72:75], v1, s[28:31], s55 offen
    s_add_u32 s55, s55, 8192
    buffer_load_dwordx4 v[76:79], v1, s[28:31], s55 offen
    s_add_u32 s55, s55, 8192
    buffer_load_dwordx4 v[80:83], v1, s[28:31], s55 offen
    s_add_u32 s55, s55, 8192
    buffer_load_dwordx4 v[84:87], v1, s[28:31], s55 offen
    s_add_u32 s55, s55, 8192
    buffer_load_dwordx4 v[88:91], v1, s[28:31], s55 offen
    s_add_u32 s55, s55, 8192
    buffer_load_dwordx4 v[92:95], v1, s[28:31], s55 offen
    s_cmp_lt_u32 s47, 6
    s_cbranch_scc1 L1_nb0
    s_barrier
L1_nb0:
    s_waitcnt vmcnt(16)
    v_perm_b32 v32, v164, v160, s44
    v_perm_b32 v33, v172, v168, s44
    v_perm_b32 v34, v180, v176, s44
    v_perm_b32 v35, v188, v184, s44
    v_perm_b32 v36, v164, v160, s45
    v_perm_b32 v37, v172, v168, s45
    v_perm_b32 v38, v180, v176, s45
    v_perm_b32 v39, v188, v184, s45
    v_mfma_f32_16x16x32_bf16 v[224:227], v[32:35], v[52:55], v[224:227]
    v_perm_b32 v32, v165, v161, s44
    v_perm_b32 v33, v173, v169, s44
    v_perm_b32 v34, v181, v177, s44
    v_perm_b32 v35, v189, v185, s44
    v_mfma_f32_16x16x32_bf16 v[228:231], v[36:39], v[52:55], v[228:231]
    v_perm_b32 v36, v165, v161, s45
    v_perm_b32 v37, v173, v169, s45
    v_perm_b32 v38, v181, v177, s45
    v_perm_b32 v39, v189, v185, s45
    v_mfma_f32_16x16x32_bf16 v[232:235], v[32:35], v[52:55], v[232:235]
    v_perm_b32 v32, v166, v162, s44
    v_perm_b32 v33, v174, v170, s44
    v_perm_b32 v34, v182, v178, s44
    v_perm_b32 v35, v190, v186, s44
    v_mfma_f32_16x16x32_bf16 v[236:239], v[36:39], v[52:55], v[236:239]
    v_perm_b32 v36, v166, v162, s45
    v_perm_b32 v37, v174, v170, s45
    v_perm_b32 v38, v182, v178, s45
    v_perm_b32 v39, v190, v186, s45
    v_mfma_f32_16x16x32_bf16 v[240:243], v[32:35], v[52:55], v[240:243]
    v_perm_b32 v32, v167, v163, s44
    v_perm_b32 v33, v175, v171, s44
    v_perm_b32 v34, v183, v179, s44
    v_perm_b32 v35, v191, v187, s44
    v_mfma_f32_16x16x32_bf16 v[244:247], v[36:39], v[52:55], v[244:247]
    v_perm_b32 v36, v167, v163, s45
    v_perm_b32 v37, v175, v171, s45
    v_perm_b32 v38, v183, v179, s45
    v_perm_b32 v39, v191, v187, s45
    v_mfma_f32_16x16x32_bf16 v[248:251], v[32:35], v[52:55], v[248:251]
    s_nop 0
    v_mfma_f32_16x16x32_bf16 v[252:255], v[36:39], v[52:55], v[252:255]
    s_waitcnt vmcnt(8)
    v_perm_b32 v32, v196, v192, s44
    v_perm_b32 v33, v204, v200, s44
    v_perm_b32 v34, v212, v208, s44
    v_perm_b32 v35, v220, v216, s44
    v_perm_b32 v36, v196, v192, s45
    v_perm_b32 v37, v204, v200, s45
    v_perm_b32 v38, v212, v208, s45
    v_perm_b32 v39, v220, v216, s45
    v_mfma_f32_16x16x32_bf16 v[224:227], v[32:35], v[56:59], v[224:227]
    v_perm_b32 v32, v197, v193, s44
    v_perm_b32 v33, v205, v201, s44
    v_perm_b32 v34, v213, v209, s44
    v_perm_b32 v35, v221, v217, s44
    v_mfma_f32_16x16x32_bf16 v[228:231], v[36:39], v[56:59], v[228:231]
    v_perm_b32 v36, v197, v193, s45
    v_perm_b32 v37, v205, v201, s45
    v_perm_b32 v38, v213, v209, s45
    v_perm_b32 v39, v221, v217, s45
    v_mfma_f32_16x16x32_bf16 v[232:235], v[32:35], v[56:59], v[232:235]
    v_perm_b32 v32, v198, v194, s44
    v_perm_b32 v33, v206, v202, s44
    v_perm_b32 v34, v214, v210, s44
    v_perm_b32 v35, v222, v218, s44
    v_mfma_f32_16x16x32_bf16 v[236:239], v[36:39], v[56:59], v[236:239]
    v_perm_b32 v36, v198, v194, s45
    v_perm_b32 v37, v206, v202, s45
    v_perm_b32 v38, v214, v210, s45
    v_perm_b32 v39, v222, v218, s45
    v_mfma_f32_16x16x32_bf16 v[240:243], v[32:35], v[56:59], v[240:243]
    v_perm_b32 v32, v199, v195, s44
    v_perm_b32 v33, v207, v203, s44
    v_perm_b32 v34, v215, v211, s44
    v_perm_b32 v35, v223, v219, s44
    v_mfma_f32_16x16x32_bf16 v[244:247], v[36:39], v[56:59], v[244:247]
    v_perm_b32 v36, v199, v195, s45
    v_perm_b32 v37, v207, v203, s45
    v_perm_b32 v38, v215, v211, s45
    v_perm_b32 v39, v223, v219, s45
    v_mfma_f32_16x16x32_bf16 v[248:251], v[32:35], v[56:59], v[248:251]
    s_nop 0
    v_mfma_f32_16x16x32_bf16 v[252:255], v[36:39], v[56:59], v[252:255]
    s_cmp_ge_u32 s47, 6
    s_cbranch_scc1 L1_nb1
    s_barrier
L1_nb1:
    s_waitcnt vmcnt(0)
    v_perm_b32 v32, v68, v64, s44
    v_perm_b32 v33, v76, v72, s44
    v_perm_b32 v34, v84, v80, s44
    v_perm_b32 v35, v92, v88, s44
    v_perm_b32 v36, v68, v64, s45
    v_perm_b32 v37, v76, v72, s45
    v_perm_b32 v38, v84, v80, s45
    v_perm_b32 v39, v92, v88, s45
    v_mfma_f32_16x16x32_bf16 v[224:227], v[32:35], v[60:63], v[224:227]
    v_perm_b32 v32, v69, v65, s44
    v_perm_b32 v33, v77, v73, s44
    v_perm_b32 v34, v85, v81, s44
    v_perm_b32 v35, v93, v89, s44
    v_mfma_f32_16x16x32_bf16 v[228:231], v[36:39], v[60:63], v[228:231]
    v_perm_b32 v36, v69, v65, s45
    v_perm_b32 v37, v77, v73, s45
    v_perm_b32 v38, v85, v81, s45
    v_perm_b32 v39, v93, v89, s45
    v_mfma_f32_16x16x32_bf16 v[232:235], v[32:35], v[60:63], v[232:235]
    v_perm_b32 v32, v70, v66, s44
    v_perm_b32 v33, v78, v74, s44
    v_perm_b32 v34, v86, v82, s44
    v_perm_b32 v35, v94, v90, s44
    v_mfma_f32_16x16x32_bf16 v[236:239], v[36:39], v[60:63], v[236:239]
    v_perm_b32 v36, v70, v66, s45
    v_perm_b32 v37, v78, v74, s45
    v_perm_b32 v38, v86, v82, s45
    v_perm_b32 v39, v94, v90, s45
    v_mfma_f32_16x16x32_bf16 v[240:243], v[32:35], v[60:63], v[240:243]
    v_perm_b32 v32, v71, v67, s44
    v_perm_b32 v33, v79, v75, s44
    v_perm_b32 v34, v87, v83, s44
    v_perm_b32 v35, v95, v91, s44
    v_mfma_f32_16x16x32_bf16 v[244:247], v[36:39], v[60:63], v[244:247]
    v_perm_b32 v36, v71, v67, s45
    v_perm_b32 v37, v79, v75, s45
    v_perm_b32 v38, v87, v83, s45
    v_perm_b32 v39, v95, v91, s45
    v_mfma_f32_16x16x32_bf16 v[248:251], v[32:35], v[60:63], v[248:251]
    s_nop 0
    v_mfma_f32_16x16x32_bf16 v[252:255], v[36:39], v[60:63], v[252:255]
    s_setprio 2
    s_mov_b64 exec, s[60:61]
    ds_write_b128 v18, v[224:227] offset:0
    ds_write_b128 v18, v[228:231] offset:16
    ds_write_b128 v18, v[232:235] offset:32
    ds_write_b128 v18, v[236:239] offset:48
    ds_write_b128 v18, v[240:243] offset:64
    ds_write_b128 v18, v[244:247] offset:80
    ds_write_b128 v18, v[248:251] offset:96
    ds_write_b128 v18, v[252:255] offset:112
    s_mov_b64 exec, -1
    v_mov_b32 v64, v0
    s_waitcnt lgkmcnt(0)
    s_barrier
    s_mov_b32 s32, s12
    s_mov_b32 s33, s13
    s_mov_b32 s34, 4718592
    s_mov_b32 s35, 0x20000
    v_lshrrev_b32 v1, 4, v64
    v_and_b32 v2, 15, v64
    v_mul_u32_u24 v1, 2304, v1
    v_mul_u32_u24 v2, 12, v2
    s_mul_i32 s53, s57, 192
    s_mul_i32 s54, s48, 294912
    s_add_u32 s53, s53, s54
    v_add3_u32 v3, v1, v2, s53
    s_and_b32 s58, s49, 7
    v_lshlrev_b32 v7, 4, v64
    s_mul_i32 s53, s57, 3072
    s_mul_i32 s55, s49, 18432
    s_add_u32 s53, s53, s54
    s_add_u32 s53, s53, s55
    buffer_load_dwordx4 v[8:11], v7, s[32:35], s53 offen offset:0 nt
    buffer_load_dwordx4 v[8:11], v7, s[32:35], s53 offen offset:1024 nt
    buffer_load_dwordx4 v[8:11], v7, s[32:35], s53 offen offset:2048 nt
    s_waitcnt vmcnt(2)
    buffer_load_dwordx4 v[8:11], v7, s[32:35], s53 offen offset:0 sc1
    s_waitcnt vmcnt(2)
    buffer_load_dwordx4 v[8:11], v7, s[32:35], s53 offen offset:1024 sc1
    s_waitcnt vmcnt(2)
    buffer_load_dwordx4 v[8:11], v7, s[32:35], s53 offen offset:2048 sc1
    s_waitcnt vmcnt(0)
    s_barrier
    s_add_u32 s53, s58, 0
    s_and_b32 s53, s53, 7
    s_mul_i32 s53, s53, 36864
    s_waitcnt vmcnt(1)
    buffer_load_dwordx3 v[224:226], v3, s[32:35], s53 offen offset:0
    s_waitcnt vmcnt(1)
    buffer_load_dwordx3 v[240:242], v3, s[32:35], s53 offen offset:1152
    s_add_u32 s53, s53, 9216
    s_waitcnt vmcnt(1)
    buffer_load_dwordx3 v[228:230], v3, s[32:35], s53 offen offset:0
    s_waitcnt vmcnt(1)
    buffer_load_dwordx3 v[244:246], v3, s[32:35], s53 offen offset:1152
    s_add_u32 s53, s53, 9216
    s_waitcnt vmcnt(1)
    buffer_load_dwordx3 v[232:234], v3, s[32:35], s53 offen offset:0
    s_waitcnt vmcnt(1)
    buffer_load_dwordx3 v[248:250], v3, s[32:35], s53 offen offset:1152
    s_add_u32 s53, s53, 9216
    s_waitcnt vmcnt(1)
    buffer_load_dwordx3 v[236:238], v3, s[32:35], s53 offen offset:0
    s_waitcnt vmcnt(1)
    buffer_load_dwordx3 v[252:254], v3, s[32:35], s53 offen offset:1152
    s_add_u32 s53, s58, 1
    s_and_b32 s53, s53, 7
    s_mul_i32 s53, s53, 36864
    s_waitcnt vmcnt(1)
    buffer_load_dwordx3 v[192:194], v3, s[32:35], s53 offen offset:0
    s_waitcnt vmcnt(1)
    buffer_load_dwordx3 v[208:210], v3, s[32:35], s53 offen offset:1152
    s_add_u32 s53, s53, 9216
    s_waitcnt vmcnt(1)
    buffer_load_dwordx3 v[196:198], v3, s[32:35], s53 offen offset:0
    s_waitcnt vmcnt(1)
    buffer_load_dwordx3 v[212:214], v3, s[32:35], s53 offen offset:1152
    s_add_u32 s53, s53, 9216
    s_waitcnt vmcnt(1)
    buffer_load_dwordx3 v[200:202], v3, s[32:35], s53 offen offset:0
    s_waitcnt vmcnt(1)
    buffer_load_dwordx3 v[216:218], v3, s[32:35], s53 offen offset:1152
    s_add_u32 s53, s53, 9216
    s_waitcnt vmcnt(1)
    buffer_load_dwordx3 v[204:206], v3, s[32:35], s53 offen offset:0
    s_waitcnt vmcnt(1)
    buffer_load_dwordx3 v[220:222], v3, s[32:35], s53 offen offset:1152
    s_add_u32 s53, s58, 2
    s_and_b32 s53, s53, 7
    s_mul_i32 s53, s53, 36864
    s_waitcnt vmcnt(1)
    buffer_load_dwordx3 v[160:162], v3, s[32:35], s53 offen offset:0
    s_waitcnt vmcnt(1)
    buffer_load_dwordx3 v[176:178], v3, s[32:35], s53 offen offset:1152
    s_add_u32 s53, s53, 9216
    s_waitcnt vmcnt(1)
    buffer_load_dwordx3 v[164:166], v3, s[32:35], s53 offen offset:0
    s_waitcnt vmcnt(1)
    buffer_load_dwordx3 v[180:182], v3, s[32:35], s53 offen offset:1152
    s_add_u32 s53, s53, 9216
    s_waitcnt vmcnt(1)
    buffer_load_dwordx3 v[168:170], v3, s[32:35], s53 offen offset:0
    s_waitcnt vmcnt(1)
    buffer_load_dwordx3 v[184:186], v3, s[32:35], s53 offen offset:1152
    s_add_u32 s53, s53, 9216
    s_waitcnt vmcnt(1)
    buffer_load_dwordx3 v[172:174], v3, s[32:35], s53 offen offset:0
    s_waitcnt vmcnt(1)
    buffer_load_dwordx3 v[188:190], v3, s[32:35], s53 offen offset:1152
    s_add_u32 s53, s58, 3
    s_and_b32 s53, s53, 7
    s_mul_i32 s53, s53, 36864
    s_waitcnt vmcnt(1)
    buffer_load_dwordx3 v[128:130], v3, s[32:35], s53 offen offset:0
    s_waitcnt vmcnt(1)
    buffer_load_dwordx3 v[144:146], v3, s[32:35], s53 offen offset:1152
    s_add_u32 s53, s53, 9216
    s_waitcnt vmcnt(1)
    buffer_load_dwordx3 v[132:134], v3, s[32:35], s53 offen offset:0
    s_waitcnt vmcnt(1)
    buffer_load_dwordx3 v[148:150], v3, s[32:35], s53 offen offset:1152
    s_add_u32 s53, s53, 9216
    s_waitcnt vmcnt(1)
    buffer_load_dwordx3 v[136:138], v3, s[32:35], s53 offen offset:0
    s_waitcnt vmcnt(1)
    buffer_load_dwordx3 v[152:154], v3, s[32:35], s53 offen offset:1152
    s_add_u32 s53, s53, 9216
    s_waitcnt vmcnt(1)
    buffer_load_dwordx3 v[140:142], v3, s[32:35], s53 offen offset:0
    s_waitcnt vmcnt(1)
    buffer_load_dwordx3 v[156:158], v3, s[32:35], s53 offen offset:1152
    s_add_u32 s53, s58, 4
    s_and_b32 s53, s53, 7
    s_mul_i32 s53, s53, 36864
    s_waitcnt vmcnt(1)
    buffer_load_dwordx3 v[96:98], v3, s[32:35], s53 offen offset:0
    s_waitcnt vmcnt(1)
    buffer_load_dwordx3 v[112:114], v3, s[32:35], s53 offen offset:1152
    s_add_u32 s53, s53, 9216
    s_waitcnt vmcnt(1)
    buffer_load_dwordx3 v[100:102], v3, s[32:35], s53 offen offset:0
    s_waitcnt vmcnt(1)
    buffer_load_dwordx3 v[116:118], v3, s[32:35], s53 offen offset:1152
    s_add_u32 s53, s53, 9216
    s_waitcnt vmcnt(1)
    buffer_load_dwordx3 v[104:106], v3, s[32:35], s53 offen offset:0
    s_waitcnt vmcnt(1)
    buffer_load_dwordx3 v[120:122], v3, s[32:35], s53 offen offset:1152
    s_add_u32 s53, s53, 9216
    s_waitcnt vmcnt(1)
    buffer_load_dwordx3 v[108:110], v3, s[32:35], s53 offen offset:0
    s_waitcnt vmcnt(1)
    buffer_load_dwordx3 v[124:126], v3, s[32:35], s53 offen offset:1152
    s_add_u32 s53, s58, 5
    s_and_b32 s53, s53, 7
    s_mul_i32 s53, s53, 36864
    s_waitcnt vmcnt(1)
    buffer_load_dwordx3 v[64:66], v3, s[32:35], s53 offen offset:0
    s_waitcnt vmcnt(1)
    buffer_load_dwordx3 v[80:82], v3, s[32:35], s53 offen offset:1152
    s_add_u32 s53, s53, 9216
    s_waitcnt vmcnt(1)
    buffer_load_dwordx3 v[68:70], v3, s[32:35], s53 offen offset:0
    s_waitcnt vmcnt(1)
    buffer_load_dwordx3 v[84:86], v3, s[32:35], s53 offen offset:1152
    s_add_u32 s53, s53, 9216
    s_waitcnt vmcnt(1)
    buffer_load_dwordx3 v[72:74], v3, s[32:35], s53 offen offset:0
    s_waitcnt vmcnt(1)
    buffer_load_dwordx3 v[88:90], v3, s[32:35], s53 offen offset:1152
    s_add_u32 s53, s53, 9216
    s_waitcnt vmcnt(1)
    buffer_load_dwordx3 v[76:78], v3, s[32:35], s53 offen offset:0
    s_waitcnt vmcnt(1)
    buffer_load_dwordx3 v[92:94], v3, s[32:35], s53 offen offset:1152
    s_add_u32 s53, s58, 6
    s_and_b32 s53, s53, 7
    s_mul_i32 s53, s53, 36864
    s_waitcnt vmcnt(1)
    buffer_load_dwordx3 v[32:34], v3, s[32:35], s53 offen offset:0
    s_waitcnt vmcnt(1)
    buffer_load_dwordx3 v[48:50], v3, s[32:35], s53 offen offset:1152
    s_add_u32 s53, s53, 9216
    s_waitcnt vmcnt(1)
    buffer_load_dwordx3 v[36:38], v3, s[32:35], s53 offen offset:0
    s_waitcnt vmcnt(1)
    buffer_load_dwordx3 v[52:54], v3, s[32:35], s53 offen offset:1152
    s_add_u32 s53, s53, 9216
    s_waitcnt vmcnt(1)
    buffer_load_dwordx3 v[40:42], v3, s[32:35], s53 offen offset:0
    s_waitcnt vmcnt(1)
    buffer_load_dwordx3 v[56:58], v3, s[32:35], s53 offen offset:1152
    s_add_u32 s53, s53, 9216
    s_waitcnt vmcnt(1)
    buffer_load_dwordx3 v[44:46], v3, s[32:35], s53 offen offset:0
    s_waitcnt vmcnt(1)
    buffer_load_dwordx3 v[60:62], v3, s[32:35], s53 offen offset:1152
    s_add_u32 s53, s58, 7
    s_and_b32 s53, s53, 7
    s_mul_i32 s53, s53, 36864
    s_waitcnt vmcnt(1)
    buffer_load_dwordx3 v[0:2], v3, s[32:35], s53 offen offset:0
    s_waitcnt vmcnt(1)
    buffer_load_dwordx3 v[16:18], v3, s[32:35], s53 offen offset:1152
    s_add_u32 s53, s53, 9216
    s_waitcnt vmcnt(1)
    buffer_load_dwordx3 v[4:6], v3, s[32:35], s53 offen offset:0
    s_waitcnt vmcnt(1)
    buffer_load_dwordx3 v[20:22], v3, s[32:35], s53 offen offset:1152
    s_add_u32 s53, s53, 9216
    s_waitcnt vmcnt(1)
    buffer_load_dwordx3 v[8:10], v3, s[32:35], s53 offen offset:0
    s_waitcnt vmcnt(1)
    buffer_load_dwordx3 v[24:26], v3, s[32:35], s53 offen offset:1152
    s_add_u32 s53, s53, 9216
    s_waitcnt vmcnt(1)
    buffer_load_dwordx3 v[12:14], v3, s[32:35], s53 offen offset:0
    s_waitcnt vmcnt(1)
    buffer_load_dwordx3 v[28:30], v3, s[32:35], s53 offen offset:1152
    s_waitcnt vmcnt(48)
    v_perm_b32 v3, v228, v224, s44
    v_perm_b32 v7, v236, v232, s44
    v_perm_b32 v11, v244, v240, s44
    v_perm_b32 v211, v252, v248, s44
    v_perm_b32 v15, v228, v224, s45
    v_perm_b32 v19, v236, v232, s45
    v_perm_b32 v23, v244, v240, s45
    v_perm_b32 v219, v252, v248, s45
    v_perm_b32 v27, v229, v225, s44
    v_perm_b32 v31, v237, v233, s44
    v_perm_b32 v35, v245, v241, s44
    v_perm_b32 v227, v253, v249, s44
    v_perm_b32 v39, v229, v225, s45
    v_perm_b32 v43, v237, v233, s45
    v_perm_b32 v47, v245, v241, s45
    v_perm_b32 v235, v253, v249, s45
    v_perm_b32 v51, v230, v226, s44
    v_perm_b32 v55, v238, v234, s44
    v_perm_b32 v59, v246, v242, s44
    v_perm_b32 v243, v254, v250, s44
    v_perm_b32 v63, v230, v226, s45
    v_perm_b32 v67, v238, v234, s45
    v_perm_b32 v71, v246, v242, s45
    v_perm_b32 v251, v254, v250, s45
    v_perm_b32 v75, v196, v192, s44
    v_perm_b32 v79, v204, v200, s44
    v_perm_b32 v83, v212, v208, s44
    v_perm_b32 v215, v220, v216, s44
    v_perm_b32 v87, v196, v192, s45
    v_perm_b32 v91, v204, v200, s45
    v_perm_b32 v95, v212, v208, s45
    v_perm_b32 v223, v220, v216, s45
    v_perm_b32 v99, v197, v193, s44
    v_perm_b32 v103, v205, v201, s44
    v_perm_b32 v107, v213, v209, s44
    v_perm_b32 v231, v221, v217, s44
    v_perm_b32 v111, v197, v193, s45
    v_perm_b32 v115, v205, v201, s45
    v_perm_b32 v119, v213, v209, s45
    v_perm_b32 v239, v221, v217, s45
    v_perm_b32 v123, v198, v194, s44
    v_perm_b32 v127, v206, v202, s44
    v_perm_b32 v131, v214, v210, s44
    v_perm_b32 v247, v222, v218, s44
    v_perm_b32 v135, v198, v194, s45
    v_perm_b32 v139, v206, v202, s45
    v_perm_b32 v143, v214, v210, s45
    v_perm_b32 v255, v222, v218, s45
    v_mov_b32 v208, v3
    v_mov_b32 v209, v7
    v_mov_b32 v210, v11
    v_mov_b32 v216, v15
    v_mov_b32 v217, v19
    v_mov_b32 v218, v23
    v_mov_b32 v224, v27
    v_mov_b32 v225, v31
    v_mov_b32 v226, v35
    v_mov_b32 v232, v39
    v_mov_b32 v233, v43
    v_mov_b32 v234, v47
    v_mov_b32 v240, v51
    v_mov_b32 v241, v55
    v_mov_b32 v242, v59
    v_mov_b32 v248, v63
    v_mov_b32 v249, v67
    v_mov_b32 v250, v71
    v_mov_b32 v212, v75
    v_mov_b32 v213, v79
    v_mov_b32 v214, v83
    v_mov_b32 v220, v87
    v_mov_b32 v221, v91
    v_mov_b32 v222, v95
    v_mov_b32 v228, v99
    v_mov_b32 v229, v103
    v_mov_b32 v230, v107
    v_mov_b32 v236, v111
    v_mov_b32 v237, v115
    v_mov_b32 v238, v119
    v_mov_b32 v244, v123
    v_mov_b32 v245, v127
    v_mov_b32 v246, v131
    v_mov_b32 v252, v135
    v_mov_b32 v253, v139
    v_mov_b32 v254, v143
    s_waitcnt vmcnt(32)
    v_perm_b32 v3, v164, v160, s44
    v_perm_b32 v7, v172, v168, s44
    v_perm_b32 v11, v180, v176, s44
    v_perm_b32 v163, v188, v184, s44
    v_perm_b32 v15, v164, v160, s45
    v_perm_b32 v19, v172, v168, s45
    v_perm_b32 v23, v180, v176, s45
    v_perm_b32 v171, v188, v184, s45
    v_perm_b32 v27, v165, v161, s44
    v_perm_b32 v31, v173, v169, s44
    v_perm_b32 v35, v181, v177, s44
    v_perm_b32 v179, v189, v185, s44
    v_perm_b32 v39, v165, v161, s45
    v_perm_b32 v43, v173, v169, s45
    v_perm_b32 v47, v181, v177, s45
    v_perm_b32 v187, v189, v185, s45
    v_perm_b32 v192, v166, v162, s44
    v_perm_b32 v193, v174, v170, s44
    v_perm_b32 v194, v182, v178, s44
    v_perm_b32 v195, v190, v186, s44
    v_perm_b32 v200, v166, v162, s45
    v_perm_b32 v201, v174, v170, s45
    v_perm_b32 v202, v182, v178, s45
    v_perm_b32 v203, v190, v186, s45
    v_perm_b32 v51, v132, v128, s44
    v_perm_b32 v55, v140, v136, s44
    v_perm_b32 v59, v148, v144, s44
    v_perm_b32 v167, v156, v152, s44
    v_perm_b32 v63, v132, v128, s45
    v_perm_b32 v67, v140, v136, s45
    v_perm_b32 v71, v148, v144, s45
    v_perm_b32 v175, v156, v152, s45
    v_perm_b32 v75, v133, v129, s44
    v_perm_b32 v79, v141, v137, s44
    v_perm_b32 v83, v149, v145, s44
    v_perm_b32 v183, v157, v153, s44
    v_perm_b32 v87, v133, v129, s45
    v_perm_b32 v91, v141, v137, s45
    v_perm_b32 v95, v149, v145, s45
    v_perm_b32 v191, v157, v153, s45
    v_perm_b32 v196, v134, v130, s44
    v_perm_b32 v197, v142, v138, s44
    v_perm_b32 v198, v150, v146, s44
    v_perm_b32 v199, v158, v154, s44
    v_perm_b32 v204, v134, v130, s45
    v_perm_b32 v205, v142, v138, s45
    v_perm_b32 v206, v150, v146, s45
    v_perm_b32 v207, v158, v154, s45
    v_mov_b32 v160, v3
    v_mov_b32 v161, v7
    v_mov_b32 v162, v11
    v_mov_b32 v168, v15
    v_mov_b32 v169, v19
    v_mov_b32 v170, v23
    v_mov_b32 v176, v27
    v_mov_b32 v177, v31
    v_mov_b32 v178, v35
    v_mov_b32 v184, v39
    v_mov_b32 v185, v43
    v_mov_b32 v186, v47
    v_mov_b32 v164, v51
    v_mov_b32 v165, v55
    v_mov_b32 v166, v59
    v_mov_b32 v172, v63
    v_mov_b32 v173, v67
    v_mov_b32 v174, v71
    v_mov_b32 v180, v75
    v_mov_b32 v181, v79
    v_mov_b32 v182, v83
    v_mov_b32 v188, v87
    v_mov_b32 v189, v91
    v_mov_b32 v190, v95
    s_waitcnt vmcnt(16)
    v_perm_b32 v3, v100, v96, s44
    v_perm_b32 v7, v108, v104, s44
    v_perm_b32 v11, v116, v112, s44
    v_perm_b32 v115, v124, v120, s44
    v_perm_b32 v15, v100, v96, s45
    v_perm_b32 v19, v108, v104, s45
    v_perm_b32 v23, v116, v112, s45
    v_perm_b32 v123, v124, v120, s45
    v_perm_b32 v128, v101, v97, s44
    v_perm_b32 v129, v109, v105, s44
    v_perm_b32 v130, v117, v113, s44
    v_perm_b32 v131, v125, v121, s44
    v_perm_b32 v136, v101, v97, s45
    v_perm_b32 v137, v109, v105, s45
    v_perm_b32 v138, v117, v113, s45
    v_perm_b32 v139, v125, v121, s45
    v_perm_b32 v144, v102, v98, s44
    v_perm_b32 v145, v110, v106, s44
    v_perm_b32 v146, v118, v114, s44
    v_perm_b32 v147, v126, v122, s44
    v_perm_b32 v152, v102, v98, s45
    v_perm_b32 v153, v110, v106, s45
    v_perm_b32 v154, v118, v114, s45
    v_perm_b32 v155, v126, v122, s45
    v_perm_b32 v27, v68, v64, s44
    v_perm_b32 v31, v76, v72, s44
    v_perm_b32 v35, v84, v80, s44
    v_perm_b32 v119, v92, v88, s44
    v_perm_b32 v39, v68, v64, s45
    v_perm_b32 v43, v76, v72, s45
    v_perm_b32 v47, v84, v80, s45
    v_perm_b32 v127, v92, v88, s45
    v_perm_b32 v132, v69, v65, s44
    v_perm_b32 v133, v77, v73, s44
    v_perm_b32 v134, v85, v81, s44
    v_perm_b32 v135, v93, v89, s44
    v_perm_b32 v140, v69, v65, s45
    v_perm_b32 v141, v77, v73, s45
    v_perm_b32 v142, v85, v81, s45
    v_perm_b32 v143, v93, v89, s45
    v_perm_b32 v148, v70, v66, s44
    v_perm_b32 v149, v78, v74, s44
    v_perm_b32 v150, v86, v82, s44
    v_perm_b32 v151, v94, v90, s44
    v_perm_b32 v156, v70, v66, s45
    v_perm_b32 v157, v78, v74, s45
    v_perm_b32 v158, v86, v82, s45
    v_perm_b32 v159, v94, v90, s45
    v_mov_b32 v112, v3
    v_mov_b32 v113, v7
    v_mov_b32 v114, v11
    v_mov_b32 v120, v15
    v_mov_b32 v121, v19
    v_mov_b32 v122, v23
    v_mov_b32 v116, v27
    v_mov_b32 v117, v31
    v_mov_b32 v118, v35
    v_mov_b32 v124, v39
    v_mov_b32 v125, v43
    v_mov_b32 v126, v47
    s_waitcnt vmcnt(0)
    v_perm_b32 v64, v36, v32, s44
    v_perm_b32 v65, v44, v40, s44
    v_perm_b32 v66, v52, v48, s44
    v_perm_b32 v67, v60, v56, s44
    v_perm_b32 v72, v36, v32, s45
    v_perm_b32 v73, v44, v40, s45
    v_perm_b32 v74, v52, v48, s45
    v_perm_b32 v75, v60, v56, s45
    v_perm_b32 v80, v37, v33, s44
    v_perm_b32 v81, v45, v41, s44
    v_perm_b32 v82, v53, v49, s44
    v_perm_b32 v83, v61, v57, s44
    v_perm_b32 v88, v37, v33, s45
    v_perm_b32 v89, v45, v41, s45
    v_perm_b32 v90, v53, v49, s45
    v_perm_b32 v91, v61, v57, s45
    v_perm_b32 v96, v38, v34, s44
    v_perm_b32 v97, v46, v42, s44
    v_perm_b32 v98, v54, v50, s44
    v_perm_b32 v99, v62, v58, s44
    v_perm_b32 v104, v38, v34, s45
    v_perm_b32 v105, v46, v42, s45
    v_perm_b32 v106, v54, v50, s45
    v_perm_b32 v107, v62, v58, s45
    v_perm_b32 v68, v4, v0, s44
    v_perm_b32 v69, v12, v8, s44
    v_perm_b32 v70, v20, v16, s44
    v_perm_b32 v71, v28, v24, s44
    v_perm_b32 v76, v4, v0, s45
    v_perm_b32 v77, v12, v8, s45
    v_perm_b32 v78, v20, v16, s45
    v_perm_b32 v79, v28, v24, s45
    v_perm_b32 v84, v5, v1, s44
    v_perm_b32 v85, v13, v9, s44
    v_perm_b32 v86, v21, v17, s44
    v_perm_b32 v87, v29, v25, s44
    v_perm_b32 v92, v5, v1, s45
    v_perm_b32 v93, v13, v9, s45
    v_perm_b32 v94, v21, v17, s45
    v_perm_b32 v95, v29, v25, s45
    v_perm_b32 v100, v6, v2, s44
    v_perm_b32 v101, v14, v10, s44
    v_perm_b32 v102, v22, v18, s44
    v_perm_b32 v103, v30, v26, s44
    v_perm_b32 v108, v6, v2, s45
    v_perm_b32 v109, v14, v10, s45
    v_perm_b32 v110, v22, v18, s45
    v_perm_b32 v111, v30, v26, s45
    v_mbcnt_lo_u32_b32 v0, -1, 0
    v_mbcnt_hi_u32_b32 v0, -1, v0
    v_lshlrev_b32 v1, 4, v0
    v_mul_u32_u24 v5, 12, v0
    v_bfe_u32 v2, v0, 1, 1
    v_mul_u32_u24 v2, 0xaaaa, v2
    v_add_u32 v2, 0x4444, v2
    s_lshl_b32 s53, s49, 4
    s_add_u32 s53, s53, s48
    s_mul_i32 s53, s53, 9216
    s_add_u32 s53, s53, 1048576
    s_add_u32 s40, s18, s53
    s_addc_u32 s41, s19, 0
    s_mov_b32 s42, 9216
    s_mov_b32 s43, 0x20000
    s_mul_i32 s55, s57, 1536
    s_add_u32 s54, s55, 768
    s_and_b32 s53, s57, 1
    s_lshl_b32 s56, s53, 10
    s_mul_i32 s53, s53, 56832
    s_add_u32 s53, s53, 82944
    v_add_u32 v6, s53, v1
    v_add_u32 v7, s56, v1
    s_cmp_lt_u32 s57, 4
    s_cbranch_scc1 L1_dw1
    ds_write_b128 v6, v[240:243] offset:0
    ds_write_b128 v6, v[244:247] offset:1024
    ds_write_b128 v6, v[192:195] offset:2048
    ds_write_b128 v6, v[196:199] offset:3072
    ds_write_b128 v6, v[144:147] offset:4096
    ds_write_b128 v6, v[148:151] offset:5120
    ds_write_b128 v6, v[96:99] offset:6144
    ds_write_b128 v6, v[100:103] offset:7168
    ds_write_b128 v6, v[248:251] offset:8192
    ds_write_b128 v6, v[252:255] offset:9216
    ds_write_b128 v6, v[200:203] offset:10240
    ds_write_b128 v6, v[204:207] offset:11264
    ds_write_b128 v6, v[152:155] offset:12288
    ds_write_b128 v6, v[156:159] offset:13312
    ds_write_b128 v6, v[104:107] offset:14336
    ds_write_b128 v6, v[108:111] offset:15360
L1_dw1:
    s_waitcnt lgkmcnt(0)
    v_mov_b32 v8, 0
    v_mov_b32 v9, 0
    v_mov_b32 v10, 0
    v_mov_b32 v11, 0
    v_mov_b32 v12, 0
    v_mov_b32 v13, 0
    v_mov_b32 v14, 0
    v_mov_b32 v15, 0
    v_mov_b32 v16, 0
    v_mov_b32 v17, 0
    v_mov_b32 v18, 0
    v_mov_b32 v19, 0
    v_mov_b32 v20, 0
    v_mov_b32 v21, 0
    v_mov_b32 v22, 0
    v_mov_b32 v23, 0
    v_mov_b32 v24, 0
    v_mov_b32 v25, 0
    v_mov_b32 v26, 0
    v_mov_b32 v27, 0
    v_mov_b32 v28, 0
    v_mov_b32 v29, 0
    v_mov_b32 v30, 0
    v_mov_b32 v31, 0
    s_barrier
    ds_read_b128 v[32:35], v1 offset:25088
    ds_read_b128 v[36:39], v1 offset:26112
    ds_read_b128 v[40:43], v1 offset:27136
    ds_read_b128 v[44:47], v1 offset:28160
    s_waitcnt lgkmcnt(3)
    v_smfmac_f32_16x16x64_bf16 v[8:11], v[32:35], v[208:215], v2
    v_smfmac_f32_16x16x64_bf16 v[12:15], v[32:35], v[216:223], v2
    v_smfmac_f32_16x16x64_bf16 v[16:19], v[32:35], v[224:231], v2
    v_smfmac_f32_16x16x64_bf16 v[20:23], v[32:35], v[232:239], v2
    v_smfmac_f32_16x16x64_bf16 v[24:27], v[32:35], v[240:247], v2
    v_smfmac_f32_16x16x64_bf16 v[28:31], v[32:35], v[248:255], v2
    s_waitcnt lgkmcnt(2)
    v_smfmac_f32_16x16x64_bf16 v[8:11], v[36:39], v[160:167], v2
    v_smfmac_f32_16x16x64_bf16 v[12:15], v[36:39], v[168:175], v2
    v_smfmac_f32_16x16x64_bf16 v[16:19], v[36:39], v[176:183], v2
    v_smfmac_f32_16x16x64_bf16 v[20:23], v[36:39], v[184:191], v2
    v_smfmac_f32_16x16x64_bf16 v[24:27], v[36:39], v[192:199], v2
    v_smfmac_f32_16x16x64_bf16 v[28:31], v[36:39], v[200:207], v2
    s_waitcnt lgkmcnt(1)
    v_smfmac_f32_16x16x64_bf16 v[8:11], v[40:43], v[112:119], v2
    v_smfmac_f32_16x16x64_bf16 v[12:15], v[40:43], v[120:127], v2
    v_smfmac_f32_16x16x64_bf16 v[16:19], v[40:43], v[128:135], v2
    v_smfmac_f32_16x16x64_bf16 v[20:23], v[40:43], v[136:143], v2
    v_smfmac_f32_16x16x64_bf16 v[24:27], v[40:43], v[144:151], v2
    v_smfmac_f32_16x16x64_bf16 v[28:31], v[40:43], v[152:159], v2
    s_waitcnt lgkmcnt(0)
    v_smfmac_f32_16x16x64_bf16 v[8:11], v[44:47], v[64:71], v2
    v_smfmac_f32_16x16x64_bf16 v[12:15], v[44:47], v[72:79], v2
    v_smfmac_f32_16x16x64_bf16 v[16:19], v[44:47], v[80:87], v2
    v_smfmac_f32_16x16x64_bf16 v[20:23], v[44:47], v[88:95], v2
    v_smfmac_f32_16x16x64_bf16 v[24:27], v[44:47], v[96:103], v2
    v_smfmac_f32_16x16x64_bf16 v[28:31], v[44:47], v[104:111], v2
    s_nop 2
    v_pk_add_f32 v[8:9], v[8:9], v[10:11]
    v_pk_add_f32 v[12:13], v[12:13], v[14:15]
    v_add_f32 v8, v8, v9
    v_add_f32 v12, v12, v13
    v_cvt_pk_bf16_f32 v48, v8, v12
    v_pk_add_f32 v[16:17], v[16:17], v[18:19]
    v_pk_add_f32 v[20:21], v[20:21], v[22:23]
    v_add_f32 v16, v16, v17
    v_add_f32 v20, v20, v21
    v_cvt_pk_bf16_f32 v49, v16, v20
    v_pk_add_f32 v[24:25], v[24:25], v[26:27]
    v_pk_add_f32 v[28:29], v[28:29], v[30:31]
    v_add_f32 v24, v24, v25
    v_add_f32 v28, v28, v29
    v_cvt_pk_bf16_f32 v50, v24, v28
    buffer_store_dwordx3 v[48:50], v5, s[40:43], s55 offen
    s_cmp_eq_u32 s57, 0
    s_cbranch_scc1 L2_stub0
    s_cmp_eq_u32 s57, 1
    s_cbranch_scc1 L2_stub1
    s_cmp_eq_u32 s57, 2
    s_cbranch_scc1 L2_stub2
    s_cmp_eq_u32 s57, 3
    s_cbranch_scc1 L2_stub3
    s_cmp_eq_u32 s57, 4
    s_cbranch_scc1 L2_stub4
L1_wret:
    v_mov_b32 v8, 0
    v_mov_b32 v9, 0
    v_mov_b32 v10, 0
    v_mov_b32 v11, 0
    v_mov_b32 v12, 0
    v_mov_b32 v13, 0
    v_mov_b32 v14, 0
    v_mov_b32 v15, 0
    v_mov_b32 v16, 0
    v_mov_b32 v17, 0
    v_mov_b32 v18, 0
    v_mov_b32 v19, 0
    v_mov_b32 v20, 0
    v_mov_b32 v21, 0
    v_mov_b32 v22, 0
    v_mov_b32 v23, 0
    v_mov_b32 v24, 0
    v_mov_b32 v25, 0
    v_mov_b32 v26, 0
    v_mov_b32 v27, 0
    v_mov_b32 v28, 0
    v_mov_b32 v29, 0
    v_mov_b32 v30, 0
    v_mov_b32 v31, 0
    s_cmp_lt_u32 s57, 4
    s_cbranch_scc1 L1_do1
    s_barrier
    ds_read_b128 v[32:35], v1 offset:29184
    ds_read_b128 v[36:39], v1 offset:30208
    ds_read_b128 v[40:43], v1 offset:31232
    ds_read_b128 v[44:47], v1 offset:32256
    s_waitcnt lgkmcnt(3)
    v_smfmac_f32_16x16x64_bf16 v[8:11], v[32:35], v[208:215], v2
    v_smfmac_f32_16x16x64_bf16 v[12:15], v[32:35], v[216:223], v2
    v_smfmac_f32_16x16x64_bf16 v[16:19], v[32:35], v[224:231], v2
    v_smfmac_f32_16x16x64_bf16 v[20:23], v[32:35], v[232:239], v2
    s_waitcnt lgkmcnt(2)
    v_smfmac_f32_16x16x64_bf16 v[8:11], v[36:39], v[160:167], v2
    v_smfmac_f32_16x16x64_bf16 v[12:15], v[36:39], v[168:175], v2
    v_smfmac_f32_16x16x64_bf16 v[16:19], v[36:39], v[176:183], v2
    v_smfmac_f32_16x16x64_bf16 v[20:23], v[36:39], v[184:191], v2
    s_waitcnt lgkmcnt(1)
    v_smfmac_f32_16x16x64_bf16 v[8:11], v[40:43], v[112:119], v2
    v_smfmac_f32_16x16x64_bf16 v[12:15], v[40:43], v[120:127], v2
    v_smfmac_f32_16x16x64_bf16 v[16:19], v[40:43], v[128:135], v2
    v_smfmac_f32_16x16x64_bf16 v[20:23], v[40:43], v[136:143], v2
    s_waitcnt lgkmcnt(0)
    v_smfmac_f32_16x16x64_bf16 v[8:11], v[44:47], v[64:71], v2
    v_smfmac_f32_16x16x64_bf16 v[12:15], v[44:47], v[72:79], v2
    v_smfmac_f32_16x16x64_bf16 v[16:19], v[44:47], v[80:87], v2
    v_smfmac_f32_16x16x64_bf16 v[20:23], v[44:47], v[88:95], v2
    s_nop 4
    v_pk_add_f32 v[8:9], v[8:9], v[10:11]
    v_pk_add_f32 v[12:13], v[12:13], v[14:15]
    v_add_f32 v8, v8, v9
    v_add_f32 v12, v12, v13
    v_cvt_pk_bf16_f32 v52, v8, v12
    v_pk_add_f32 v[16:17], v[16:17], v[18:19]
    v_pk_add_f32 v[20:21], v[20:21], v[22:23]
    v_add_f32 v16, v16, v17
    v_add_f32 v20, v20, v21
    v_cvt_pk_bf16_f32 v53, v16, v20
    buffer_store_dwordx2 v[52:53], v5, s[40:43], s54 offen
    s_endpgm
L1_do1:
    s_barrier
    ds_read_b128 v[32:35], v1 offset:29184
    ds_read_b128 v[36:39], v1 offset:30208
    ds_read_b128 v[40:43], v1 offset:31232
    ds_read_b128 v[44:47], v1 offset:32256
    s_waitcnt lgkmcnt(3)
    v_smfmac_f32_16x16x64_bf16 v[8:11], v[32:35], v[208:215], v2
    v_smfmac_f32_16x16x64_bf16 v[12:15], v[32:35], v[216:223], v2
    v_smfmac_f32_16x16x64_bf16 v[16:19], v[32:35], v[224:231], v2
    v_smfmac_f32_16x16x64_bf16 v[20:23], v[32:35], v[232:239], v2
    v_smfmac_f32_16x16x64_bf16 v[24:27], v[32:35], v[240:247], v2
    v_smfmac_f32_16x16x64_bf16 v[28:31], v[32:35], v[248:255], v2
    s_waitcnt lgkmcnt(2)
    v_smfmac_f32_16x16x64_bf16 v[8:11], v[36:39], v[160:167], v2
    v_smfmac_f32_16x16x64_bf16 v[12:15], v[36:39], v[168:175], v2
    v_smfmac_f32_16x16x64_bf16 v[16:19], v[36:39], v[176:183], v2
    v_smfmac_f32_16x16x64_bf16 v[20:23], v[36:39], v[184:191], v2
    v_smfmac_f32_16x16x64_bf16 v[24:27], v[36:39], v[192:199], v2
    v_smfmac_f32_16x16x64_bf16 v[28:31], v[36:39], v[200:207], v2
    s_waitcnt lgkmcnt(1)
    v_smfmac_f32_16x16x64_bf16 v[8:11], v[40:43], v[112:119], v2
    v_smfmac_f32_16x16x64_bf16 v[12:15], v[40:43], v[120:127], v2
    v_smfmac_f32_16x16x64_bf16 v[16:19], v[40:43], v[128:135], v2
    v_smfmac_f32_16x16x64_bf16 v[20:23], v[40:43], v[136:143], v2
    v_smfmac_f32_16x16x64_bf16 v[24:27], v[40:43], v[144:151], v2
    v_smfmac_f32_16x16x64_bf16 v[28:31], v[40:43], v[152:159], v2
    s_waitcnt lgkmcnt(0)
    v_smfmac_f32_16x16x64_bf16 v[8:11], v[44:47], v[64:71], v2
    v_smfmac_f32_16x16x64_bf16 v[12:15], v[44:47], v[72:79], v2
    v_smfmac_f32_16x16x64_bf16 v[16:19], v[44:47], v[80:87], v2
    v_smfmac_f32_16x16x64_bf16 v[20:23], v[44:47], v[88:95], v2
    v_smfmac_f32_16x16x64_bf16 v[24:27], v[44:47], v[96:103], v2
    v_smfmac_f32_16x16x64_bf16 v[28:31], v[44:47], v[104:111], v2
    s_nop 2
    v_pk_add_f32 v[8:9], v[8:9], v[10:11]
    v_pk_add_f32 v[12:13], v[12:13], v[14:15]
    v_add_f32 v8, v8, v9
    v_add_f32 v12, v12, v13
    v_cvt_pk_bf16_f32 v52, v8, v12
    v_pk_add_f32 v[16:17], v[16:17], v[18:19]
    v_pk_add_f32 v[20:21], v[20:21], v[22:23]
    v_add_f32 v16, v16, v17
    v_add_f32 v20, v20, v21
    v_cvt_pk_bf16_f32 v53, v16, v20
    v_pk_add_f32 v[24:25], v[24:25], v[26:27]
    v_pk_add_f32 v[28:29], v[28:29], v[30:31]
    v_add_f32 v24, v24, v25
    v_add_f32 v28, v28, v29
    v_cvt_pk_bf16_f32 v54, v24, v28
    buffer_store_dwordx3 v[52:54], v5, s[40:43], s54 offen
L1_fin:
L1_end:
    s_endpgm
.globl gqa_reduce_kernel
.p2align 8
.type gqa_reduce_kernel,@function
gqa_reduce_kernel:
    s_cmp_ge_u32 s2, 144
    s_cbranch_scc1 L2_end
    s_load_dwordx2 s[6:7], s[0:1], 56
    s_load_dwordx2 s[4:5], s[0:1], 40
    s_movk_i32 s20, 0x3f80
    s_movk_i32 s19, 9216
    s_and_b32 s3, s2, 15
    s_lshr_b32 s2, s2, 4
L2_walk:
    s_branch L2_skip0
L2_stub0:
    s_branch L1_wret
L2_skip0:
    v_and_b32 v2, 15, v0
    v_bfe_u32 v3, v0, 4, 2
    v_and_b32 v4, 0x3c0, v0
    s_mul_i32 s16, s3, 147456
    s_mul_i32 s17, s2, 1024
    v_lshlrev_b32 v4, 3, v4
    v_lshl_add_u32 v4, v2, 4, v4
    s_add_u32 s16, s16, s17
    s_add_u32 s16, s16, 1048576
    v_mad_u32_u24 v8, v3, s19, v4
    v_add_u32 v8, s16, v8
    v_add_u32 v9, 36864, v8
    v_add_u32 v10, 73728, v8
    v_add_u32 v11, 110592, v8
    s_branch L2_skip1
L2_stub1:
    s_branch L1_wret
L2_skip1:
    s_waitcnt lgkmcnt(0)
    global_load_dwordx4 v[24:27], v8, s[6:7] offset:0
    global_load_dwordx4 v[28:31], v8, s[6:7] offset:256
    global_load_dwordx4 v[32:35], v9, s[6:7] offset:0
    global_load_dwordx4 v[36:39], v9, s[6:7] offset:256
    global_load_dwordx4 v[40:43], v10, s[6:7] offset:0
    global_load_dwordx4 v[44:47], v10, s[6:7] offset:256
    global_load_dwordx4 v[48:51], v11, s[6:7] offset:0
    global_load_dwordx4 v[52:55], v11, s[6:7] offset:256
L2_w1:
    v_and_b32 v5, 1, v0
    v_lshlrev_b32 v5, 4, v5
    v_lshlrev_b32 v5, v5, s20
    v_lshrrev_b32 v6, 1, v2
    v_cmp_eq_u32 s[32:33], 0, v6
    v_cmp_eq_u32 s[34:35], 1, v6
    v_cmp_eq_u32 s[36:37], 2, v6
    v_cmp_eq_u32 s[38:39], 3, v6
    s_branch L2_skip2
L2_stub2:
    s_branch L1_wret
L2_skip2:
    v_cmp_eq_u32 s[40:41], 4, v6
    v_cmp_eq_u32 s[42:43], 5, v6
    v_cmp_eq_u32 s[44:45], 6, v6
    v_cmp_eq_u32 s[46:47], 7, v6
    v_cndmask_b32 v16, 0, v5, s[32:33]
    v_cndmask_b32 v17, 0, v5, s[34:35]
    v_cndmask_b32 v18, 0, v5, s[36:37]
    v_cndmask_b32 v19, 0, v5, s[38:39]
    v_cndmask_b32 v20, 0, v5, s[40:41]
    v_cndmask_b32 v21, 0, v5, s[42:43]
    v_cndmask_b32 v22, 0, v5, s[44:45]
    v_cndmask_b32 v23, 0, v5, s[46:47]
    s_mul_i32 s18, s3, 9216
    v_lshrrev_b32 v6, 1, v3
    v_lshl_add_u32 v4, v6, 8, v4
    s_branch L2_skip3
L2_stub3:
    s_branch L1_wret
L2_skip3:
    v_and_b32 v6, 1, v3
    v_lshl_add_u32 v4, v6, 3, v4
    v_add_u32 v4, s17, v4
    v_lshrrev_b32 v6, 6, v4
    v_mul_u32_u24 v6, 21846, v6
    v_bfe_u32 v7, v6, 16, 3
    v_lshrrev_b32 v6, 19, v6
    v_mul_u32_u24 v7, 960, v7
    v_mul_u32_u24 v6, 1344, v6
    v_add_u32 v4, v4, v7
    v_sub_u32 v4, v4, v6
    v_add_u32 v4, s18, v4
    s_waitcnt vmcnt(7)
    v_mfma_f32_16x16x32_bf16 v[12:15], v[16:19], v[24:27], 0
    s_waitcnt vmcnt(6)
    v_mfma_f32_16x16x32_bf16 v[12:15], v[20:23], v[28:31], v[12:15]
    s_waitcnt vmcnt(5)
    v_mfma_f32_16x16x32_bf16 v[12:15], v[16:19], v[32:35], v[12:15]
    s_waitcnt vmcnt(4)
    v_mfma_f32_16x16x32_bf16 v[12:15], v[20:23], v[36:39], v[12:15]
    s_waitcnt vmcnt(3)
    v_mfma_f32_16x16x32_bf16 v[12:15], v[16:19], v[40:43], v[12:15]
    s_waitcnt vmcnt(2)
    v_mfma_f32_16x16x32_bf16 v[12:15], v[20:23], v[44:47], v[12:15]
    s_waitcnt vmcnt(1)
    v_mfma_f32_16x16x32_bf16 v[12:15], v[16:19], v[48:51], v[12:15]
    s_waitcnt vmcnt(0)
    v_mfma_f32_16x16x32_bf16 v[12:15], v[20:23], v[52:55], v[12:15]
    s_nop 7
    v_cvt_pk_bf16_f32 v8, v12, v13
    v_cvt_pk_bf16_f32 v9, v14, v15
    global_store_dwordx2 v4, v[8:9], s[4:5]
L2_end:
    s_endpgm
L2_stub4:
    s_branch L1_wret
.section .rodata,"a"
.p2align 6
.amdhsa_kernel gqa_main_kernel
  .amdhsa_next_free_vgpr 256
  .amdhsa_next_free_sgpr 96
  .amdhsa_accum_offset 256
  .amdhsa_group_segment_fixed_size 0
  .amdhsa_kernarg_size 64
  .amdhsa_user_sgpr_count 2
  .amdhsa_user_sgpr_kernarg_segment_ptr 1
  .amdhsa_system_sgpr_workgroup_id_x 1
.end_amdhsa_kernel
.p2align 6
.amdhsa_kernel gqa_reduce_kernel
  .amdhsa_next_free_vgpr 56
  .amdhsa_next_free_sgpr 48
  .amdhsa_accum_offset 56
  .amdhsa_group_segment_fixed_size 0
  .amdhsa_kernarg_size 64
  .amdhsa_user_sgpr_count 2
  .amdhsa_user_sgpr_kernarg_segment_ptr 1
  .amdhsa_system_sgpr_workgroup_id_x 1
.end_amdhsa_kernel
```
